```python
import torch

def _softmax(x, axis=-1):
    return torch.softmax(x, dim=axis)
def _gelu(x):
    return torch.nn.functional.gelu(x, approximate="tanh")
def _silu(x):
    return torch.nn.functional.silu(x)
def _sigmoid(x):
    return torch.sigmoid(x)
def _layernorm(x, axis=-1, eps=1e-5):
    m = x.mean(dim=axis, keepdim=True)
    v = x.var(dim=axis, keepdim=True, unbiased=False)
    return (x - m) / torch.sqrt(v + eps)
def _scatter_add(tgt, idx, src, axis=0):
    return tgt.clone().index_add_(axis, idx, src)
def _segment_sum(src, seg, n):
    out = torch.zeros((n,) + src.shape[1:], dtype=src.dtype)
    return out.index_add_(0, seg, src)
def _pad(x, pw):
    flat = tuple(v for pair in reversed(pw) for v in pair)
    return torch.nn.functional.pad(x, flat)

kernel_name = 'sequential_preLN__mha_block_cached__geglu_ffn__decode'

def setup_inputs():

    _w = (lambda a: (lambda t: t.to(torch.bfloat16) if t.is_floating_point() else t)(torch.as_tensor(a)))
    def _A_setup():
        B, Sq, D = 1, 1, 512
        H, Sk, Dh = 32, 4096, 128
        return {
            "x": _w((lambda *s: torch.randn(*s, dtype=torch.bfloat16) * 0.05)(B, Sq, D)),
            "k_cache": _w((lambda *s: torch.randn(*s, dtype=torch.bfloat16) * 3.2)(B, H, Sk, Dh)),
            "v_cache": _w((lambda *s: torch.randn(*s, dtype=torch.bfloat16) * 0.4)(B, H, Sk, Dh)),
            "wq": _w((lambda *s: torch.randn(*s, dtype=torch.bfloat16) * 3.2)(D, H * Dh) * (D ** -0.5)),
            "wo": _w((lambda *s: torch.randn(*s, dtype=torch.bfloat16) * 0.4)(H * Dh, D) * ((H * Dh) ** -0.5)),
        }
    _A_in = _A_setup()

    def _B_setup():
        B, S, D, F = 1, 1, 512, 1376
        return {
            "x": _w((lambda *s: torch.randn(*s, dtype=torch.bfloat16) * 0.05)(B, S, D)),
            "w_gate": _w((lambda *s: torch.randn(*s, dtype=torch.bfloat16) * 0.05)(D, F)),
            "w_up": _w((lambda *s: torch.randn(*s, dtype=torch.bfloat16) * 0.05)(D, F)),
            "w_down": _w((lambda *s: torch.randn(*s, dtype=torch.bfloat16) * 0.05)(F, D)),
        }
    _B_in = _B_setup()

    return {
        "A_x": _A_in["x"],
        "A_k_cache": _A_in["k_cache"],
        "A_v_cache": _A_in["v_cache"],
        "A_wq": _A_in["wq"],
        "A_wo": _A_in["wo"],
        "B_x": _B_in["x"],
        "B_w_gate": _B_in["w_gate"],
        "B_w_up": _B_in["w_up"],
        "B_w_down": _B_in["w_down"],
    }

def reference(A_x, A_k_cache, A_v_cache, A_wq, A_wo, B_x, B_w_gate, B_w_up, B_w_down):
    def _A_ref(x, k_cache, v_cache, wq, wo):
        B, Sq, D = x.shape
        H, Dh = 32, 128
        q = (lambda x, *d: x.permute(*d))((x @ wq).reshape(B, Sq, H, Dh), 0, 2, 1, 3)
        scores = torch.einsum("bhqd,bhkd->bhqk", q, k_cache) * (Dh ** -0.5)
        p = _softmax(scores, axis=-1)
        o = torch.einsum("bhqk,bhkd->bhqd", p, v_cache)
        return (lambda x, *d: x.permute(*d))(o, 0, 2, 1, 3).reshape(B, Sq, H * Dh) @ wo

    def _B_ref(x, w_gate, w_up, w_down):
        return (_gelu(x @ w_gate) * (x @ w_up)) @ w_down

    x = A_x
    h = x + _A_ref(_layernorm(x, axis=-1), A_k_cache, A_v_cache, A_wq, A_wo)
    h2 = h + _B_ref(_layernorm(h, axis=-1), B_w_gate, B_w_up, B_w_down)
    return h2
```

```asm
; @launch grid=(256,1,1) block=(512,1,1) lds=157440
.amdgcn_target "amdgcn-amd-amdhsa--gfx950"
.text
.globl sequential_preLN__mha_block_cached__geglu_ffn__decode_kernel
.p2align 8
.type sequential_preLN__mha_block_cached__geglu_ffn__decode_kernel,@function
sequential_preLN__mha_block_cached__geglu_ffn__decode_kernel:
    s_cmp_ge_u32 s2, 256
    s_cbranch_scc1 L_end
    s_load_dwordx16 s[4:19], s[0:1], 0
    s_load_dwordx8 s[20:27], s[0:1], 64
    s_add_u32 s3, s2, 1
    s_and_b32 s3, s3, 7
    s_andn2_b32 s2, s2, 7
    s_or_b32 s2, s2, s3
    v_lshrrev_b32 v1, 6, v0
    v_and_b32 v0, 63, v0
    v_readfirstlane_b32 s28, v1
    s_lshr_b32 s29, s2, 3
    s_and_b32 s30, s2, 7
    v_lshrrev_b32 v2, 4, v0
    v_and_b32 v3, 15, v0
    v_lshlrev_b32 v4, 4, v0
    s_cmp_eq_u32 s30, 7
    s_cbranch_scc1 L_tail
    s_cmp_lt_u32 s28, 4
    s_cbranch_scc1 L_kwave
    s_cmp_eq_u32 s28, 4
    s_cbranch_scc0 L_vwave
    s_setprio 3
    v_lshlrev_b32 v5, 17, v2
    v_lshl_add_u32 v5, v3, 4, v5
    s_mul_i32 s31, s30, 76
    v_add_lshl_u32 v6, v0, s31, 1
    v_mul_u32_u24 v22, 3, v2
    v_add_u32 v23, v22, v3
    v_add_u32 v23, 64, v23
    v_add_lshl_u32 v23, v23, s31, 1
    v_lshlrev_b32 v22, 13, v22
    v_lshl_add_u32 v22, v3, 4, v22
    s_lshl_b32 s31, s31, 13
    s_lshl_b32 s57, s29, 8
    s_add_u32 s31, s31, s57
    s_sub_u32 s57, 0x400000, s31
    s_waitcnt lgkmcnt(0)
    s_mov_b32 s36, s4
    s_mov_b32 s37, s5
    s_mov_b32 s38, 1024
    s_mov_b32 s39, 0x20000
    s_add_u32 s40, s10, s31
    s_addc_u32 s41, s11, 0
    s_mov_b32 s42, s57
    s_mov_b32 s43, 0x20000
    buffer_load_dwordx4 v[16:19], v4, s[36:39], 0 offen
    buffer_load_ushort v20, v6, s[36:39], 0 offen
    buffer_load_ushort v21, v23, s[36:39], 0 offen
    buffer_load_dwordx4 v[64:67], v5, s[40:43], 0 offen
    s_mov_b32 s31, 8192
    buffer_load_dwordx4 v[68:71], v5, s[40:43], s31 offen
    s_mov_b32 s31, 16384
    buffer_load_dwordx4 v[72:75], v5, s[40:43], s31 offen
    s_mov_b32 s31, 24576
    buffer_load_dwordx4 v[76:79], v5, s[40:43], s31 offen
    s_mov_b32 s31, 32768
    buffer_load_dwordx4 v[80:83], v5, s[40:43], s31 offen
    s_mov_b32 s31, 40960
    buffer_load_dwordx4 v[84:87], v5, s[40:43], s31 offen
    s_mov_b32 s31, 49152
    buffer_load_dwordx4 v[88:91], v5, s[40:43], s31 offen
    s_mov_b32 s31, 57344
    buffer_load_dwordx4 v[92:95], v5, s[40:43], s31 offen
    s_mov_b32 s31, 65536
    buffer_load_dwordx4 v[96:99], v5, s[40:43], s31 offen
    s_mov_b32 s31, 73728
    buffer_load_dwordx4 v[100:103], v5, s[40:43], s31 offen
    s_mov_b32 s31, 81920
    buffer_load_dwordx4 v[104:107], v5, s[40:43], s31 offen
    s_mov_b32 s31, 90112
    buffer_load_dwordx4 v[108:111], v5, s[40:43], s31 offen
    s_mov_b32 s31, 98304
    buffer_load_dwordx4 v[112:115], v5, s[40:43], s31 offen
    s_mov_b32 s31, 106496
    buffer_load_dwordx4 v[116:119], v5, s[40:43], s31 offen
    s_mov_b32 s31, 114688
    buffer_load_dwordx4 v[120:123], v5, s[40:43], s31 offen
    s_mov_b32 s31, 122880
    buffer_load_dwordx4 v[124:127], v5, s[40:43], s31 offen
    s_mov_b32 s31, 524288
    buffer_load_dwordx4 v[128:131], v22, s[40:43], s31 offen
    s_mov_b32 s31, 532480
    buffer_load_dwordx4 v[132:135], v22, s[40:43], s31 offen
    s_mov_b32 s31, 540672
    buffer_load_dwordx4 v[136:139], v22, s[40:43], s31 offen
    v_mov_b32 v7, 157184
    v_mov_b32 v22, 0xff800000
    v_mov_b32 v23, 0
    ds_write_b32 v7, v22
    ds_write_b32 v7, v23 offset:4
    ds_write_b32 v7, v23 offset:8
    ds_write_b32 v7, v23 offset:12
    s_waitcnt lgkmcnt(0)
    s_add_u32 s96, s26, 598016
    s_addc_u32 s97, s27, 0
    s_load_dword s98, s[96:97], 0
    s_mov_b32 s44, s26
    s_mov_b32 s45, s27
    s_mov_b32 s46, 602112
    s_mov_b32 s47, 0x20000
    v_and_b32 v5, 1, v3
    v_lshlrev_b32 v5, 4, v5
    v_mov_b32 v6, 0xffff
    v_lshlrev_b32 v5, v5, v6
    v_lshrrev_b32 v6, 1, v3
    v_cmp_eq_u32 s[32:33], 0, v6
    v_cmp_eq_u32 s[34:35], 1, v6
    v_cmp_eq_u32 s[60:61], 2, v6
    v_cmp_eq_u32 s[62:63], 3, v6
    v_cndmask_b32 v8, 0, v5, s[32:33]
    v_cndmask_b32 v9, 0, v5, s[34:35]
    v_cndmask_b32 v10, 0, v5, s[60:61]
    v_cndmask_b32 v11, 0, v5, s[62:63]
    s_waitcnt vmcnt(19)
    v_lshlrev_b32 v40, 16, v16
    v_and_b32 v41, 0xffff0000, v16
    v_lshlrev_b32 v42, 16, v17
    v_and_b32 v43, 0xffff0000, v17
    v_lshlrev_b32 v44, 16, v18
    v_and_b32 v45, 0xffff0000, v18
    v_lshlrev_b32 v46, 16, v19
    v_and_b32 v47, 0xffff0000, v19
    v_lshlrev_b32 v20, 16, v20
    v_lshlrev_b32 v21, 16, v21
    v_add_f32 v48, v40, v41
    v_add_f32 v49, v42, v43
    v_add_f32 v50, v44, v45
    v_add_f32 v51, v46, v47
    v_add_f32 v48, v48, v49
    v_add_f32 v50, v50, v51
    v_add_f32 v48, v48, v50
    s_nop 1
    v_add_f32_dpp v48, v48, v48 quad_perm:[1,0,3,2] row_mask:0xf bank_mask:0xf
    s_nop 1
    v_add_f32_dpp v48, v48, v48 quad_perm:[2,3,0,1] row_mask:0xf bank_mask:0xf
    s_nop 1
    v_add_f32_dpp v48, v48, v48 row_half_mirror row_mask:0xf bank_mask:0xf
    s_nop 1
    v_add_f32_dpp v48, v48, v48 row_mirror row_mask:0xf bank_mask:0xf
    s_nop 1
    v_add_f32_dpp v48, v48, v48 row_bcast:15 row_mask:0xa bank_mask:0xf
    s_nop 1
    v_add_f32_dpp v48, v48, v48 row_bcast:31 row_mask:0xc bank_mask:0xf
    s_nop 0
    v_readlane_b32 s31, v48, 63
    s_nop 1
    v_mov_b32 v52, 0x3b000000
    v_mul_f32 v52, s31, v52
    v_sub_f32 v40, v40, v52
    v_sub_f32 v41, v41, v52
    v_sub_f32 v42, v42, v52
    v_sub_f32 v43, v43, v52
    v_sub_f32 v44, v44, v52
    v_sub_f32 v45, v45, v52
    v_sub_f32 v46, v46, v52
    v_sub_f32 v47, v47, v52
    v_mul_f32 v48, v40, v40
    v_mul_f32 v49, v41, v41
    v_fmac_f32 v48, v42, v42
    v_fmac_f32 v49, v43, v43
    v_fmac_f32 v48, v44, v44
    v_fmac_f32 v49, v45, v45
    v_fmac_f32 v48, v46, v46
    v_fmac_f32 v49, v47, v47
    v_add_f32 v48, v48, v49
    s_nop 1
    v_add_f32_dpp v48, v48, v48 quad_perm:[1,0,3,2] row_mask:0xf bank_mask:0xf
    s_nop 1
    v_add_f32_dpp v48, v48, v48 quad_perm:[2,3,0,1] row_mask:0xf bank_mask:0xf
    s_nop 1
    v_add_f32_dpp v48, v48, v48 row_half_mirror row_mask:0xf bank_mask:0xf
    s_nop 1
    v_add_f32_dpp v48, v48, v48 row_mirror row_mask:0xf bank_mask:0xf
    s_nop 1
    v_add_f32_dpp v48, v48, v48 row_bcast:15 row_mask:0xa bank_mask:0xf
    s_nop 1
    v_add_f32_dpp v48, v48, v48 row_bcast:31 row_mask:0xc bank_mask:0xf
    s_nop 0
    v_readlane_b32 s31, v48, 63
    s_nop 1
    v_mov_b32 v53, 0x3b000000
    v_mul_f32 v53, s31, v53
    v_cvt_pk_bf16_f32 v48, v52, v53
    v_and_b32 v53, 0xffff0000, v48
    v_lshlrev_b32 v52, 16, v48
    v_add_f32 v53, 0x3727c5ac, v53
    v_sub_f32 v49, v20, v52
    v_cvt_pk_bf16_f32 v48, v49, v53
    v_and_b32 v53, 0xffff0000, v48
    v_sqrt_f32 v53, v53
    v_lshlrev_b32 v49, 16, v48
    v_cvt_pk_bf16_f32 v53, v53, v53
    v_and_b32 v53, 0xffff0000, v53
    v_rcp_f32 v53, v53
    s_nop 0
    v_mul_f32 v49, v49, v53
    v_cvt_pk_bf16_f32 v22, v49, v49
    v_sub_f32 v49, v21, v52
    v_cvt_pk_bf16_f32 v49, v49, v49
    v_and_b32 v49, 0xffff0000, v49
    v_mul_f32 v49, v49, v53
    v_cvt_pk_bf16_f32 v23, v49, v49
    s_nop 1
    v_and_b32_dpp v24, v22, v8 row_newbcast:0 row_mask:0xf bank_mask:0xf
    v_and_b32_dpp v25, v22, v9 row_newbcast:0 row_mask:0xf bank_mask:0xf
    v_and_b32_dpp v26, v22, v10 row_newbcast:0 row_mask:0xf bank_mask:0xf
    v_and_b32_dpp v27, v22, v11 row_newbcast:0 row_mask:0xf bank_mask:0xf
    v_and_b32_dpp v28, v22, v8 row_newbcast:1 row_mask:0xf bank_mask:0xf
    v_and_b32_dpp v29, v22, v9 row_newbcast:1 row_mask:0xf bank_mask:0xf
    v_and_b32_dpp v30, v22, v10 row_newbcast:1 row_mask:0xf bank_mask:0xf
    v_and_b32_dpp v31, v22, v11 row_newbcast:1 row_mask:0xf bank_mask:0xf
    s_waitcnt vmcnt(18)
    v_mfma_f32_16x16x32_bf16 v[32:35], v[24:27], v[64:67], 0
    v_and_b32_dpp v24, v22, v8 row_newbcast:2 row_mask:0xf bank_mask:0xf
    v_and_b32_dpp v25, v22, v9 row_newbcast:2 row_mask:0xf bank_mask:0xf
    v_and_b32_dpp v26, v22, v10 row_newbcast:2 row_mask:0xf bank_mask:0xf
    v_and_b32_dpp v27, v22, v11 row_newbcast:2 row_mask:0xf bank_mask:0xf
    s_waitcnt vmcnt(17)
    v_mfma_f32_16x16x32_bf16 v[32:35], v[28:31], v[68:71], v[32:35]
    v_and_b32_dpp v28, v22, v8 row_newbcast:3 row_mask:0xf bank_mask:0xf
    v_and_b32_dpp v29, v22, v9 row_newbcast:3 row_mask:0xf bank_mask:0xf
    v_and_b32_dpp v30, v22, v10 row_newbcast:3 row_mask:0xf bank_mask:0xf
    v_and_b32_dpp v31, v22, v11 row_newbcast:3 row_mask:0xf bank_mask:0xf
    s_waitcnt vmcnt(16)
    v_mfma_f32_16x16x32_bf16 v[32:35], v[24:27], v[72:75], v[32:35]
    v_and_b32_dpp v24, v22, v8 row_newbcast:4 row_mask:0xf bank_mask:0xf
    v_and_b32_dpp v25, v22, v9 row_newbcast:4 row_mask:0xf bank_mask:0xf
    v_and_b32_dpp v26, v22, v10 row_newbcast:4 row_mask:0xf bank_mask:0xf
    v_and_b32_dpp v27, v22, v11 row_newbcast:4 row_mask:0xf bank_mask:0xf
    s_waitcnt vmcnt(15)
    v_mfma_f32_16x16x32_bf16 v[32:35], v[28:31], v[76:79], v[32:35]
    v_and_b32_dpp v28, v22, v8 row_newbcast:5 row_mask:0xf bank_mask:0xf
    v_and_b32_dpp v29, v22, v9 row_newbcast:5 row_mask:0xf bank_mask:0xf
    v_and_b32_dpp v30, v22, v10 row_newbcast:5 row_mask:0xf bank_mask:0xf
    v_and_b32_dpp v31, v22, v11 row_newbcast:5 row_mask:0xf bank_mask:0xf
    s_waitcnt vmcnt(14)
    v_mfma_f32_16x16x32_bf16 v[32:35], v[24:27], v[80:83], v[32:35]
    v_and_b32_dpp v24, v22, v8 row_newbcast:6 row_mask:0xf bank_mask:0xf
    v_and_b32_dpp v25, v22, v9 row_newbcast:6 row_mask:0xf bank_mask:0xf
    v_and_b32_dpp v26, v22, v10 row_newbcast:6 row_mask:0xf bank_mask:0xf
    v_and_b32_dpp v27, v22, v11 row_newbcast:6 row_mask:0xf bank_mask:0xf
    s_waitcnt vmcnt(13)
    v_mfma_f32_16x16x32_bf16 v[32:35], v[28:31], v[84:87], v[32:35]
    v_and_b32_dpp v28, v22, v8 row_newbcast:7 row_mask:0xf bank_mask:0xf
    v_and_b32_dpp v29, v22, v9 row_newbcast:7 row_mask:0xf bank_mask:0xf
    v_and_b32_dpp v30, v22, v10 row_newbcast:7 row_mask:0xf bank_mask:0xf
    v_and_b32_dpp v31, v22, v11 row_newbcast:7 row_mask:0xf bank_mask:0xf
    s_waitcnt vmcnt(12)
    v_mfma_f32_16x16x32_bf16 v[32:35], v[24:27], v[88:91], v[32:35]
    v_and_b32_dpp v24, v22, v8 row_newbcast:8 row_mask:0xf bank_mask:0xf
    v_and_b32_dpp v25, v22, v9 row_newbcast:8 row_mask:0xf bank_mask:0xf
    v_and_b32_dpp v26, v22, v10 row_newbcast:8 row_mask:0xf bank_mask:0xf
    v_and_b32_dpp v27, v22, v11 row_newbcast:8 row_mask:0xf bank_mask:0xf
    s_waitcnt vmcnt(11)
    v_mfma_f32_16x16x32_bf16 v[32:35], v[28:31], v[92:95], v[32:35]
    v_and_b32_dpp v28, v22, v8 row_newbcast:9 row_mask:0xf bank_mask:0xf
    v_and_b32_dpp v29, v22, v9 row_newbcast:9 row_mask:0xf bank_mask:0xf
    v_and_b32_dpp v30, v22, v10 row_newbcast:9 row_mask:0xf bank_mask:0xf
    v_and_b32_dpp v31, v22, v11 row_newbcast:9 row_mask:0xf bank_mask:0xf
    s_waitcnt vmcnt(10)
    v_mfma_f32_16x16x32_bf16 v[32:35], v[24:27], v[96:99], v[32:35]
    v_and_b32_dpp v24, v22, v8 row_newbcast:10 row_mask:0xf bank_mask:0xf
    v_and_b32_dpp v25, v22, v9 row_newbcast:10 row_mask:0xf bank_mask:0xf
    v_and_b32_dpp v26, v22, v10 row_newbcast:10 row_mask:0xf bank_mask:0xf
    v_and_b32_dpp v27, v22, v11 row_newbcast:10 row_mask:0xf bank_mask:0xf
    s_waitcnt vmcnt(9)
    v_mfma_f32_16x16x32_bf16 v[32:35], v[28:31], v[100:103], v[32:35]
    v_and_b32_dpp v28, v22, v8 row_newbcast:11 row_mask:0xf bank_mask:0xf
    v_and_b32_dpp v29, v22, v9 row_newbcast:11 row_mask:0xf bank_mask:0xf
    v_and_b32_dpp v30, v22, v10 row_newbcast:11 row_mask:0xf bank_mask:0xf
    v_and_b32_dpp v31, v22, v11 row_newbcast:11 row_mask:0xf bank_mask:0xf
    s_waitcnt vmcnt(8)
    v_mfma_f32_16x16x32_bf16 v[32:35], v[24:27], v[104:107], v[32:35]
    v_and_b32_dpp v24, v22, v8 row_newbcast:12 row_mask:0xf bank_mask:0xf
    v_and_b32_dpp v25, v22, v9 row_newbcast:12 row_mask:0xf bank_mask:0xf
    v_and_b32_dpp v26, v22, v10 row_newbcast:12 row_mask:0xf bank_mask:0xf
    v_and_b32_dpp v27, v22, v11 row_newbcast:12 row_mask:0xf bank_mask:0xf
    s_waitcnt vmcnt(7)
    v_mfma_f32_16x16x32_bf16 v[32:35], v[28:31], v[108:111], v[32:35]
    v_and_b32_dpp v28, v22, v8 row_newbcast:13 row_mask:0xf bank_mask:0xf
    v_and_b32_dpp v29, v22, v9 row_newbcast:13 row_mask:0xf bank_mask:0xf
    v_and_b32_dpp v30, v22, v10 row_newbcast:13 row_mask:0xf bank_mask:0xf
    v_and_b32_dpp v31, v22, v11 row_newbcast:13 row_mask:0xf bank_mask:0xf
    s_waitcnt vmcnt(6)
    v_mfma_f32_16x16x32_bf16 v[32:35], v[24:27], v[112:115], v[32:35]
    v_and_b32_dpp v24, v22, v8 row_newbcast:14 row_mask:0xf bank_mask:0xf
    v_and_b32_dpp v25, v22, v9 row_newbcast:14 row_mask:0xf bank_mask:0xf
    v_and_b32_dpp v26, v22, v10 row_newbcast:14 row_mask:0xf bank_mask:0xf
    v_and_b32_dpp v27, v22, v11 row_newbcast:14 row_mask:0xf bank_mask:0xf
    s_waitcnt vmcnt(5)
    v_mfma_f32_16x16x32_bf16 v[32:35], v[28:31], v[116:119], v[32:35]
    v_and_b32_dpp v28, v22, v8 row_newbcast:15 row_mask:0xf bank_mask:0xf
    v_and_b32_dpp v29, v22, v9 row_newbcast:15 row_mask:0xf bank_mask:0xf
    v_and_b32_dpp v30, v22, v10 row_newbcast:15 row_mask:0xf bank_mask:0xf
    v_and_b32_dpp v31, v22, v11 row_newbcast:15 row_mask:0xf bank_mask:0xf
    s_waitcnt vmcnt(4)
    v_mfma_f32_16x16x32_bf16 v[32:35], v[24:27], v[120:123], v[32:35]
    v_and_b32_dpp v24, v23, v8 row_newbcast:0 row_mask:0xf bank_mask:0xf
    v_and_b32_dpp v25, v23, v9 row_newbcast:0 row_mask:0xf bank_mask:0xf
    v_and_b32_dpp v26, v23, v10 row_newbcast:0 row_mask:0xf bank_mask:0xf
    v_and_b32_dpp v27, v23, v11 row_newbcast:0 row_mask:0xf bank_mask:0xf
    s_waitcnt vmcnt(3)
    v_mfma_f32_16x16x32_bf16 v[32:35], v[28:31], v[124:127], v[32:35]
    v_and_b32_dpp v28, v23, v8 row_newbcast:1 row_mask:0xf bank_mask:0xf
    v_and_b32_dpp v29, v23, v9 row_newbcast:1 row_mask:0xf bank_mask:0xf
    v_and_b32_dpp v30, v23, v10 row_newbcast:1 row_mask:0xf bank_mask:0xf
    v_and_b32_dpp v31, v23, v11 row_newbcast:1 row_mask:0xf bank_mask:0xf
    s_waitcnt vmcnt(2)
    v_mfma_f32_16x16x32_bf16 v[32:35], v[24:27], v[128:131], v[32:35]
    v_and_b32_dpp v24, v23, v8 row_newbcast:2 row_mask:0xf bank_mask:0xf
    v_and_b32_dpp v25, v23, v9 row_newbcast:2 row_mask:0xf bank_mask:0xf
    v_and_b32_dpp v26, v23, v10 row_newbcast:2 row_mask:0xf bank_mask:0xf
    v_and_b32_dpp v27, v23, v11 row_newbcast:2 row_mask:0xf bank_mask:0xf
    s_waitcnt vmcnt(1)
    v_mfma_f32_16x16x32_bf16 v[32:35], v[28:31], v[132:135], v[32:35]
    s_nop 1
    s_waitcnt vmcnt(0)
    v_mfma_f32_16x16x32_bf16 v[32:35], v[24:27], v[136:139], v[32:35]
    s_waitcnt lgkmcnt(0)
    s_add_u32 s101, s98, 1
    s_mul_i32 s98, s98, 0x9e3779b1
    s_and_b32 s99, s101, 0xff
    s_add_u32 s98, s98, 0x7f4a7c15
    s_mov_b32 s100, 0xffffff00
    s_and_b32 s94, s101, 0xf
    s_mov_b32 s95, 0xfffffff0
    s_lshl_b32 s57, s2, 10
    v_lshlrev_b32 v5, 5, v3
    v_lshl_add_u32 v5, v2, 4, v5
    v_mov_b32 v1, s94
    s_nop 1
    s_mov_b32 exec_lo, 0xffffffff
    s_mov_b32 exec_hi, 0
    v_and_or_b32 v32, v32, s95, v1
    v_and_or_b32 v33, v33, s95, v1
    v_and_or_b32 v34, v34, s95, v1
    v_and_or_b32 v35, v35, s95, v1
    buffer_store_dwordx4 v[32:35], v5, s[44:47], s57 offen sc1
    s_mov_b64 exec, -1
    s_setprio 0
    s_barrier
    s_branch L_vcommon
L_kwave:
    v_add_u32 v5, 0, v2
    v_xor_b32 v5, v5, v3
    v_lshlrev_b32 v5, 4, v5
    v_lshl_add_u32 v36, v2, 8, v5
    v_add_u32 v5, 4, v2
    v_xor_b32 v5, v5, v3
    v_lshlrev_b32 v5, 4, v5
    v_lshl_add_u32 v37, v2, 8, v5
    v_add_u32 v5, 8, v2
    v_xor_b32 v5, v5, v3
    v_lshlrev_b32 v5, 4, v5
    v_lshl_add_u32 v38, v2, 8, v5
    v_add_u32 v5, 12, v2
    v_xor_b32 v5, v5, v3
    v_lshlrev_b32 v5, 4, v5
    v_lshl_add_u32 v39, v2, 8, v5
    s_lshr_b32 s31, s30, 1
    s_mul_i32 s31, s31, 300032
    s_lshl_b32 s57, s29, 20
    s_add_u32 s31, s31, s57
    s_bitcmp1_b32 s30, 0
    s_cselect_b32 s57, 148480, 0
    s_cselect_b32 s54, 3072, 0
    s_add_u32 s54, s54, 148480
    s_add_u32 s31, s31, s57
    s_mov_b32 s55, 0x20000
    s_lshl_b32 s57, s28, 12
    s_lshl_b32 s58, s29, 13
    s_mov_b32 m0, s57
    v_add_u32 v58, 0x1000, v4
    s_waitcnt lgkmcnt(0)
    s_add_u32 s52, s6, s31
    s_addc_u32 s53, s7, 0
    v_lshlrev_b32 v57, 3, v0
    v_add_u32 v58, 0x1000, v57
    buffer_load_dwordx4 v36, s[52:55], s57 offen offset:0 nt lds
    buffer_load_dwordx4 v37, s[52:55], s57 offen offset:1024 nt lds
    buffer_load_dwordx4 v38, s[52:55], s57 offen offset:2048 nt lds
    buffer_load_dwordx4 v39, s[52:55], s57 offen offset:3072 nt lds
    s_add_u32 s57, s57, 16384
    s_cmp_eq_u32 s28, 1
    s_cbranch_scc0 L_nopfa
    s_getpc_b64 s[32:33]
L_pca:
    s_sub_u32 s32, s32, L_pca - sequential_preLN__mha_block_cached__geglu_ffn__decode_kernel
    s_subb_u32 s33, s33, 0
    v_and_b32 v5, 3, v0
    v_lshlrev_b32 v5, 5, v5
    v_add_lshl_u32 v5, v5, s29, 7
    v_min_u32 v6, L_end - sequential_preLN__mha_block_cached__geglu_ffn__decode_kernel, v5
    global_load_dword v254, v6, s[32:33]
L_nopfa:
    s_add_u32 s96, s26, 598016
    s_addc_u32 s97, s27, 0
    s_load_dword s98, s[96:97], 0
    s_mov_b32 s44, s26
    s_mov_b32 s45, s27
    s_mov_b32 s46, 602112
    s_mov_b32 s47, 0x20000
    s_mov_b32 m0, s57
    s_nop 0
    buffer_load_dwordx4 v36, s[52:55], s57 offen offset:0 nt lds
    buffer_load_dwordx4 v37, s[52:55], s57 offen offset:1024 nt lds
    buffer_load_dwordx4 v38, s[52:55], s57 offen offset:2048 nt lds
    buffer_load_dwordx4 v39, s[52:55], s57 offen offset:3072 nt lds
    s_add_u32 s57, s57, 16384
    s_mov_b32 m0, s57
    s_nop 0
    buffer_load_dwordx4 v36, s[52:55], s57 offen offset:0 nt lds
    buffer_load_dwordx4 v37, s[52:55], s57 offen offset:1024 nt lds
    buffer_load_dwordx4 v38, s[52:55], s57 offen offset:2048 nt lds
    buffer_load_dwordx4 v39, s[52:55], s57 offen offset:3072 nt lds
    s_add_u32 s57, s57, 16384
    s_mov_b32 m0, s57
    s_nop 0
    buffer_load_dwordx4 v36, s[52:55], s57 offen offset:0 nt lds
    buffer_load_dwordx4 v37, s[52:55], s57 offen offset:1024 nt lds
    buffer_load_dwordx4 v38, s[52:55], s57 offen offset:2048 nt lds
    buffer_load_dwordx4 v39, s[52:55], s57 offen offset:3072 nt lds
    s_add_u32 s57, s57, 16384
    s_mov_b32 m0, s57
    s_nop 0
    buffer_load_dwordx4 v36, s[52:55], s57 offen offset:0 nt lds
    buffer_load_dwordx4 v37, s[52:55], s57 offen offset:1024 nt lds
    buffer_load_dwordx4 v38, s[52:55], s57 offen offset:2048 nt lds
    buffer_load_dwordx4 v39, s[52:55], s57 offen offset:3072 nt lds
    s_add_u32 s57, s57, 16384
    s_mov_b32 m0, s57
    s_nop 0
    buffer_load_dwordx4 v36, s[52:55], s57 offen offset:0 nt lds
    buffer_load_dwordx4 v37, s[52:55], s57 offen offset:1024 nt lds
    buffer_load_dwordx4 v38, s[52:55], s57 offen offset:2048 nt lds
    buffer_load_dwordx4 v39, s[52:55], s57 offen offset:3072 nt lds
    s_add_u32 s57, s57, 16384
    s_mov_b32 m0, s57
    s_nop 0
    buffer_load_dwordx4 v36, s[52:55], s57 offen offset:0 nt lds
    buffer_load_dwordx4 v37, s[52:55], s57 offen offset:1024 nt lds
    buffer_load_dwordx4 v38, s[52:55], s57 offen offset:2048 nt lds
    buffer_load_dwordx4 v39, s[52:55], s57 offen offset:3072 nt lds
    s_add_u32 s57, s57, 16384
    s_barrier
    s_mov_b32 m0, s57
    s_nop 0
    buffer_load_dwordx4 v36, s[52:55], s57 offen offset:0 nt lds
    buffer_load_dwordx4 v37, s[52:55], s57 offen offset:1024 nt lds
    buffer_load_dwordx4 v38, s[52:55], s57 offen offset:2048 nt lds
    buffer_load_dwordx4 v39, s[52:55], s57 offen offset:3072 nt lds
    s_add_u32 s57, s57, 16384
    s_mov_b32 m0, s57
    s_nop 0
    buffer_load_dwordx4 v36, s[52:55], s57 offen offset:0 nt lds
    buffer_load_dwordx4 v37, s[52:55], s57 offen offset:1024 nt lds
    buffer_load_dwordx4 v38, s[52:55], s57 offen offset:2048 nt lds
    buffer_load_dwordx4 v39, s[52:55], s57 offen offset:3072 nt lds
    s_add_u32 s57, s57, 16384
    buffer_load_dwordx2 v[140:141], v57, s[44:47], s58 offen offset:0 sc1
    buffer_load_dwordx2 v[142:143], v57, s[44:47], s58 offen offset:1024 sc1
    buffer_load_dwordx2 v[144:145], v57, s[44:47], s58 offen offset:2048 sc1
    buffer_load_dwordx2 v[146:147], v57, s[44:47], s58 offen offset:3072 sc1
    buffer_load_dwordx2 v[148:149], v58, s[44:47], s58 offen offset:0 sc1
    buffer_load_dwordx2 v[150:151], v58, s[44:47], s58 offen offset:1024 sc1
    buffer_load_dwordx2 v[152:153], v58, s[44:47], s58 offen offset:2048 sc1
    s_cmp_eq_u32 s28, 0
    s_cbranch_scc0 L_kcommon
    s_mov_b32 m0, s57
    s_nop 0
    buffer_load_dwordx4 v36, s[52:55], s57 offen offset:0 nt lds
    buffer_load_dwordx4 v37, s[52:55], s57 offen offset:1024 nt lds
    buffer_load_dwordx4 v38, s[52:55], s57 offen offset:2048 nt lds
    buffer_load_dwordx4 v39, s[52:55], s57 offen offset:3072 nt lds
    s_add_u32 s57, s57, 16384
L_kcommon:
    s_waitcnt lgkmcnt(0)
    s_add_u32 s101, s98, 1
    s_mul_i32 s98, s98, 0x9e3779b1
    s_and_b32 s99, s101, 0xff
    s_add_u32 s98, s98, 0x7f4a7c15
    s_mov_b32 s100, 0xffffff00
    s_and_b32 s94, s101, 0xf
    s_mov_b32 s95, 0xfffffff0
    s_mov_b32 s59, 0
    s_branch L_poll_1_c
L_poll_1:
    buffer_load_dwordx2 v[140:141], v57, s[44:47], s58 offen offset:0 sc1
    buffer_load_dwordx2 v[142:143], v57, s[44:47], s58 offen offset:1024 sc1
    buffer_load_dwordx2 v[144:145], v57, s[44:47], s58 offen offset:2048 sc1
    buffer_load_dwordx2 v[146:147], v57, s[44:47], s58 offen offset:3072 sc1
    buffer_load_dwordx2 v[148:149], v58, s[44:47], s58 offen offset:0 sc1
    buffer_load_dwordx2 v[150:151], v58, s[44:47], s58 offen offset:1024 sc1
    buffer_load_dwordx2 v[152:153], v58, s[44:47], s58 offen offset:2048 sc1
L_poll_1_c:
    s_waitcnt vmcnt(0)
    v_xor_b32 v140, s94, v140
    v_xor_b32 v141, s94, v141
    v_xor_b32 v142, s94, v142
    v_xor_b32 v143, s94, v143
    v_xor_b32 v144, s94, v144
    v_xor_b32 v145, s94, v145
    v_xor_b32 v146, s94, v146
    v_xor_b32 v147, s94, v147
    v_xor_b32 v148, s94, v148
    v_xor_b32 v149, s94, v149
    v_xor_b32 v150, s94, v150
    v_xor_b32 v151, s94, v151
    v_xor_b32 v152, s94, v152
    v_xor_b32 v153, s94, v153
    v_or3_b32 v6, v140, v141, v142
    v_or3_b32 v6, v6, v143, v144
    v_or3_b32 v6, v6, v145, v146
    v_or3_b32 v6, v6, v147, v148
    v_or3_b32 v6, v6, v149, v150
    v_or3_b32 v6, v6, v151, v152
    v_or_b32 v6, v6, v153
    v_and_b32 v6, 0xf, v6
    v_cmp_ne_u32 vcc, 0, v6
    s_nop 1
    s_cbranch_vccz L_poll_1_x
    s_add_u32 s59, s59, 1
    s_cmp_gt_u32 s59, 1048576
    s_cbranch_scc1 L_poll_1_x
    s_sleep 4
    s_branch L_poll_1
    .p2align 5
L_poll_1_x:
    v_add_f32 v40, v140, v142
    v_add_f32 v41, v141, v143
    v_add_f32 v40, v40, v144
    v_add_f32 v41, v41, v145
    v_add_f32 v40, v40, v146
    v_add_f32 v41, v41, v147
    v_add_f32 v40, v40, v148
    v_add_f32 v41, v41, v149
    v_add_f32 v40, v40, v150
    v_add_f32 v41, v41, v151
    v_add_f32 v40, v40, v152
    v_add_f32 v41, v41, v153
    v_cvt_pk_bf16_f32 v40, v40, v41
    s_lshl_b32 s57, s28, 8
    s_add_u32 s57, s57, 154112
    v_lshl_add_u32 v5, v0, 2, s57
    v_lshl_add_u32 v6, v2, 4, s57
    ds_write_b32 v5, v40
    ds_read_b128 v[44:47], v6 offset:0
    ds_read_b128 v[48:51], v6 offset:64
    ds_read_b128 v[52:55], v6 offset:128
    ds_read_b128 v[56:59], v6 offset:192
    s_lshl_b32 s57, s28, 12
    v_add_u32 v5, 0, v2
    v_xor_b32 v5, v5, v3
    v_lshlrev_b32 v5, 4, v5
    v_lshl_add_u32 v5, v3, 8, v5
    v_add_u32 v36, s57, v5
    v_add_u32 v5, 4, v2
    v_xor_b32 v5, v5, v3
    v_lshlrev_b32 v5, 4, v5
    v_lshl_add_u32 v5, v3, 8, v5
    v_add_u32 v37, s57, v5
    v_add_u32 v5, 8, v2
    v_xor_b32 v5, v5, v3
    v_lshlrev_b32 v5, 4, v5
    v_lshl_add_u32 v5, v3, 8, v5
    v_add_u32 v38, s57, v5
    v_add_u32 v5, 12, v2
    v_xor_b32 v5, v5, v3
    v_lshlrev_b32 v5, 4, v5
    v_lshl_add_u32 v5, v3, 8, v5
    v_add_u32 v39, s57, v5
    s_mov_b32 s32, 0x00010001
    s_mov_b32 s33, 0x00010001
    ds_read_b128 v[64:67], v36 offset:0
    ds_read_b128 v[68:71], v37 offset:0
    ds_read_b128 v[72:75], v38 offset:0
    ds_read_b128 v[76:79], v39 offset:0
    ds_read_b128 v[80:83], v36 offset:16384
    ds_read_b128 v[84:87], v37 offset:16384
    ds_read_b128 v[88:91], v38 offset:16384
    ds_read_b128 v[92:95], v39 offset:16384
    s_waitcnt lgkmcnt(4)
    v_mfma_f32_16x16x32_bf16 v[100:103], v[64:67], v[44:47], 0
    v_mfma_f32_16x16x32_bf16 v[100:103], v[68:71], v[48:51], v[100:103]
    v_mfma_f32_16x16x32_bf16 v[100:103], v[72:75], v[52:55], v[100:103]
    v_mfma_f32_16x16x32_bf16 v[100:103], v[76:79], v[56:59], v[100:103]
    ds_read_b128 v[64:67], v36 offset:32768
    ds_read_b128 v[68:71], v37 offset:32768
    ds_read_b128 v[72:75], v38 offset:32768
    ds_read_b128 v[76:79], v39 offset:32768
    s_waitcnt lgkmcnt(4)
    v_mfma_f32_16x16x32_bf16 v[104:107], v[80:83], v[44:47], 0
    v_mfma_f32_16x16x32_bf16 v[104:107], v[84:87], v[48:51], v[104:107]
    v_mfma_f32_16x16x32_bf16 v[104:107], v[88:91], v[52:55], v[104:107]
    v_mfma_f32_16x16x32_bf16 v[104:107], v[92:95], v[56:59], v[104:107]
    ds_read_b128 v[80:83], v36 offset:49152
    ds_read_b128 v[84:87], v37 offset:49152
    ds_read_b128 v[88:91], v38 offset:49152
    ds_read_b128 v[92:95], v39 offset:49152
    s_waitcnt lgkmcnt(4)
    v_mfma_f32_16x16x32_bf16 v[108:111], v[64:67], v[44:47], 0
    v_mfma_f32_16x16x32_bf16 v[108:111], v[68:71], v[48:51], v[108:111]
    v_mfma_f32_16x16x32_bf16 v[108:111], v[72:75], v[52:55], v[108:111]
    v_mfma_f32_16x16x32_bf16 v[108:111], v[76:79], v[56:59], v[108:111]
    v_add_u32 v36, 0x10000, v36
    v_add_u32 v37, 0x10000, v37
    v_add_u32 v38, 0x10000, v38
    v_add_u32 v39, 0x10000, v39
    ds_read_b128 v[64:67], v36 offset:0
    ds_read_b128 v[68:71], v37 offset:0
    ds_read_b128 v[72:75], v38 offset:0
    ds_read_b128 v[76:79], v39 offset:0
    s_waitcnt lgkmcnt(4)
    v_mfma_f32_16x16x32_bf16 v[112:115], v[80:83], v[44:47], 0
    v_mfma_f32_16x16x32_bf16 v[112:115], v[84:87], v[48:51], v[112:115]
    v_mfma_f32_16x16x32_bf16 v[112:115], v[88:91], v[52:55], v[112:115]
    v_mfma_f32_16x16x32_bf16 v[112:115], v[92:95], v[56:59], v[112:115]
    ds_read_b128 v[80:83], v36 offset:16384
    ds_read_b128 v[84:87], v37 offset:16384
    ds_read_b128 v[88:91], v38 offset:16384
    ds_read_b128 v[92:95], v39 offset:16384
    s_lshl_b64 s[34:35], s[32:33], 1
    v_cndmask_b32 v100, v100, v104, s[34:35]
    v_cndmask_b32 v101, v101, v105, s[34:35]
    v_cndmask_b32 v102, v102, v106, s[34:35]
    v_cndmask_b32 v103, v103, v107, s[34:35]
    s_waitcnt lgkmcnt(4)
    v_mfma_f32_16x16x32_bf16 v[116:119], v[64:67], v[44:47], 0
    v_mfma_f32_16x16x32_bf16 v[116:119], v[68:71], v[48:51], v[116:119]
    v_mfma_f32_16x16x32_bf16 v[116:119], v[72:75], v[52:55], v[116:119]
    v_mfma_f32_16x16x32_bf16 v[116:119], v[76:79], v[56:59], v[116:119]
    ds_read_b128 v[64:67], v36 offset:32768
    ds_read_b128 v[68:71], v37 offset:32768
    ds_read_b128 v[72:75], v38 offset:32768
    ds_read_b128 v[76:79], v39 offset:32768
    s_lshl_b64 s[34:35], s[32:33], 2
    v_cndmask_b32 v100, v100, v108, s[34:35]
    v_cndmask_b32 v101, v101, v109, s[34:35]
    v_cndmask_b32 v102, v102, v110, s[34:35]
    v_cndmask_b32 v103, v103, v111, s[34:35]
    s_waitcnt lgkmcnt(4)
    v_mfma_f32_16x16x32_bf16 v[120:123], v[80:83], v[44:47], 0
    v_mfma_f32_16x16x32_bf16 v[120:123], v[84:87], v[48:51], v[120:123]
    v_mfma_f32_16x16x32_bf16 v[120:123], v[88:91], v[52:55], v[120:123]
    v_mfma_f32_16x16x32_bf16 v[120:123], v[92:95], v[56:59], v[120:123]
    ds_read_b128 v[80:83], v36 offset:49152
    ds_read_b128 v[84:87], v37 offset:49152
    ds_read_b128 v[88:91], v38 offset:49152
    ds_read_b128 v[92:95], v39 offset:49152
    s_lshl_b64 s[34:35], s[32:33], 3
    v_cndmask_b32 v100, v100, v112, s[34:35]
    v_cndmask_b32 v101, v101, v113, s[34:35]
    v_cndmask_b32 v102, v102, v114, s[34:35]
    v_cndmask_b32 v103, v103, v115, s[34:35]
    s_waitcnt lgkmcnt(4)
    v_mfma_f32_16x16x32_bf16 v[124:127], v[64:67], v[44:47], 0
    v_mfma_f32_16x16x32_bf16 v[124:127], v[68:71], v[48:51], v[124:127]
    v_mfma_f32_16x16x32_bf16 v[124:127], v[72:75], v[52:55], v[124:127]
    v_mfma_f32_16x16x32_bf16 v[124:127], v[76:79], v[56:59], v[124:127]
    v_add_u32 v36, 0x10000, v36
    v_add_u32 v37, 0x10000, v37
    v_add_u32 v38, 0x10000, v38
    v_add_u32 v39, 0x10000, v39
    ds_read_b128 v[64:67], v36 offset:0
    ds_read_b128 v[68:71], v37 offset:0
    ds_read_b128 v[72:75], v38 offset:0
    ds_read_b128 v[76:79], v39 offset:0
    s_lshl_b64 s[34:35], s[32:33], 4
    v_cndmask_b32 v100, v100, v116, s[34:35]
    v_cndmask_b32 v101, v101, v117, s[34:35]
    v_cndmask_b32 v102, v102, v118, s[34:35]
    v_cndmask_b32 v103, v103, v119, s[34:35]
    s_waitcnt lgkmcnt(4)
    v_mfma_f32_16x16x32_bf16 v[128:131], v[80:83], v[44:47], 0
    v_mfma_f32_16x16x32_bf16 v[128:131], v[84:87], v[48:51], v[128:131]
    v_mfma_f32_16x16x32_bf16 v[128:131], v[88:91], v[52:55], v[128:131]
    v_mfma_f32_16x16x32_bf16 v[128:131], v[92:95], v[56:59], v[128:131]
    ds_read_b128 v[80:83], v36 offset:16384
    ds_read_b128 v[84:87], v37 offset:16384
    ds_read_b128 v[88:91], v38 offset:16384
    ds_read_b128 v[92:95], v39 offset:16384
    s_lshl_b64 s[34:35], s[32:33], 5
    v_cndmask_b32 v100, v100, v120, s[34:35]
    v_cndmask_b32 v101, v101, v121, s[34:35]
    v_cndmask_b32 v102, v102, v122, s[34:35]
    v_cndmask_b32 v103, v103, v123, s[34:35]
    s_waitcnt lgkmcnt(4)
    v_mfma_f32_16x16x32_bf16 v[132:135], v[64:67], v[44:47], 0
    v_mfma_f32_16x16x32_bf16 v[132:135], v[68:71], v[48:51], v[132:135]
    v_mfma_f32_16x16x32_bf16 v[132:135], v[72:75], v[52:55], v[132:135]
    v_mfma_f32_16x16x32_bf16 v[132:135], v[76:79], v[56:59], v[132:135]
    s_lshl_b64 s[34:35], s[32:33], 6
    v_cndmask_b32 v100, v100, v124, s[34:35]
    v_cndmask_b32 v101, v101, v125, s[34:35]
    v_cndmask_b32 v102, v102, v126, s[34:35]
    v_cndmask_b32 v103, v103, v127, s[34:35]
    s_waitcnt lgkmcnt(0)
    v_mfma_f32_16x16x32_bf16 v[136:139], v[80:83], v[44:47], 0
    v_mfma_f32_16x16x32_bf16 v[136:139], v[84:87], v[48:51], v[136:139]
    v_mfma_f32_16x16x32_bf16 v[136:139], v[88:91], v[52:55], v[136:139]
    v_mfma_f32_16x16x32_bf16 v[136:139], v[92:95], v[56:59], v[136:139]
    s_lshl_b64 s[34:35], s[32:33], 7
    v_cndmask_b32 v100, v100, v128, s[34:35]
    v_cndmask_b32 v101, v101, v129, s[34:35]
    v_cndmask_b32 v102, v102, v130, s[34:35]
    v_cndmask_b32 v103, v103, v131, s[34:35]
    s_lshl_b64 s[34:35], s[32:33], 8
    v_cndmask_b32 v100, v100, v132, s[34:35]
    v_cndmask_b32 v101, v101, v133, s[34:35]
    v_cndmask_b32 v102, v102, v134, s[34:35]
    v_cndmask_b32 v103, v103, v135, s[34:35]
    s_nop 7
    s_lshl_b64 s[34:35], s[32:33], 9
    v_cndmask_b32 v100, v100, v136, s[34:35]
    v_cndmask_b32 v101, v101, v137, s[34:35]
    v_cndmask_b32 v102, v102, v138, s[34:35]
    v_cndmask_b32 v103, v103, v139, s[34:35]
    v_cvt_pk_bf16_f32 v40, v100, v101
    v_cvt_pk_bf16_f32 v41, v102, v103
    v_lshlrev_b32 v100, 16, v40
    v_and_b32 v101, 0xffff0000, v40
    v_lshlrev_b32 v102, 16, v41
    v_and_b32 v103, 0xffff0000, v41
    v_mul_f32 v100, 0x3db504f3, v100
    v_mul_f32 v101, 0x3db504f3, v101
    v_mul_f32 v102, 0x3db504f3, v102
    v_mul_f32 v103, 0x3db504f3, v103
    v_cvt_pk_bf16_f32 v40, v100, v101
    v_cvt_pk_bf16_f32 v41, v102, v103
    v_lshlrev_b32 v100, 16, v40
    v_and_b32 v101, 0xffff0000, v40
    v_lshlrev_b32 v102, 16, v41
    v_and_b32 v103, 0xffff0000, v41
    s_lshl_b32 s31, s28, 4
    v_lshlrev_b32 v5, 6, v3
    v_lshl_add_u32 v5, v2, 2, v5
    v_add_u32 v5, s31, v5
    s_lshr_b32 s31, s54, 8
    s_sub_u32 s56, s31, 1
    s_sub_u32 s57, s31, 2
    v_cmp_gt_u32 s[32:33], s31, v5
    s_sub_u32 s31, s31, 3
    v_cmp_gt_u32 s[34:35], s56, v5
    v_cmp_gt_u32 s[60:61], s57, v5
    v_cmp_gt_u32 s[62:63], s31, v5
    v_mov_b32 v6, 0xff800000
    v_cndmask_b32 v100, v6, v100, s[32:33]
    v_cndmask_b32 v101, v6, v101, s[34:35]
    v_cndmask_b32 v102, v6, v102, s[60:61]
    v_cndmask_b32 v103, v6, v103, s[62:63]
    v_max3_f32 v6, v100, v101, v102
    v_max_f32 v6, v6, v103
    s_nop 1
    v_max_f32_dpp v6, v6, v6 quad_perm:[1,0,3,2] row_mask:0xf bank_mask:0xf
    s_nop 1
    v_max_f32_dpp v6, v6, v6 quad_perm:[2,3,0,1] row_mask:0xf bank_mask:0xf
    s_nop 1
    v_max_f32_dpp v6, v6, v6 row_half_mirror row_mask:0xf bank_mask:0xf
    s_nop 1
    v_max_f32_dpp v6, v6, v6 row_mirror row_mask:0xf bank_mask:0xf
    s_nop 1
    v_max_f32_dpp v6, v6, v6 row_bcast:15 row_mask:0xa bank_mask:0xf
    s_nop 1
    v_max_f32_dpp v6, v6, v6 row_bcast:31 row_mask:0xc bank_mask:0xf
    s_nop 0
    v_readlane_b32 s31, v6, 63
    s_nop 1
    v_mov_b32 v6, s31
    v_mov_b32 v7, 157184
    v_mov_b32 v40, 1
    s_mov_b32 exec_lo, 0x1
    s_mov_b32 exec_hi, 0
    ds_max_f32 v7, v6
    ds_add_u32 v7, v40 offset:4
    s_mov_b64 exec, -1
    s_mov_b32 s59, 0
L_lspin_2:
    ds_read_b32 v6, v7 offset:4
    s_waitcnt lgkmcnt(0)
    v_readfirstlane_b32 s31, v6
    s_nop 0
    s_cmp_ge_u32 s31, 4
    s_cbranch_scc1 L_lspin_2_x
    s_add_u32 s59, s59, 1
    s_cmp_gt_u32 s59, 1048576
    s_cbranch_scc1 L_lspin_2_x
    s_sleep 1
    s_branch L_lspin_2
L_lspin_2_x:
    ds_read_b32 v41, v7
    s_waitcnt lgkmcnt(0)
    v_sub_f32 v100, v100, v41
    v_sub_f32 v101, v101, v41
    v_sub_f32 v102, v102, v41
    v_sub_f32 v103, v103, v41
    v_mul_f32 v100, 0x3fb8aa3b, v100
    v_mul_f32 v101, 0x3fb8aa3b, v101
    v_mul_f32 v102, 0x3fb8aa3b, v102
    v_mul_f32 v103, 0x3fb8aa3b, v103
    v_exp_f32 v100, v100
    v_exp_f32 v101, v101
    v_exp_f32 v102, v102
    v_exp_f32 v103, v103
    v_lshlrev_b32 v5, 2, v5
    v_add_u32 v5, 151552, v5
    v_add_f32 v6, v100, v101
    v_add_f32 v42, v102, v103
    v_cvt_pk_bf16_f32 v104, v100, v100
    v_cvt_pk_bf16_f32 v105, v101, v101
    v_cvt_pk_bf16_f32 v106, v102, v102
    v_cvt_pk_bf16_f32 v107, v103, v103
    v_add_f32 v6, v6, v42
    s_mov_b32 exec_lo, 0x03ff03ff
    s_mov_b32 exec_hi, 0x03ff03ff
    ds_write_b128 v5, v[104:107]
    s_mov_b64 exec, -1
    s_nop 1
    v_add_f32_dpp v6, v6, v6 quad_perm:[1,0,3,2] row_mask:0xf bank_mask:0xf
    s_nop 1
    v_add_f32_dpp v6, v6, v6 quad_perm:[2,3,0,1] row_mask:0xf bank_mask:0xf
    s_nop 1
    v_add_f32_dpp v6, v6, v6 row_half_mirror row_mask:0xf bank_mask:0xf
    s_nop 1
    v_add_f32_dpp v6, v6, v6 row_mirror row_mask:0xf bank_mask:0xf
    s_nop 1
    v_add_f32_dpp v6, v6, v6 row_bcast:15 row_mask:0xa bank_mask:0xf
    s_nop 1
    v_add_f32_dpp v6, v6, v6 row_bcast:31 row_mask:0xc bank_mask:0xf
    s_nop 0
    v_readlane_b32 s31, v6, 63
    s_nop 1
    v_mov_b32 v6, s31
    s_lshl_b32 s31, s28, 2
    v_add_u32 v42, s31, v7
    s_mov_b32 exec_lo, 0x1
    s_mov_b32 exec_hi, 0
    ds_write_b32 v42, v6 offset:16
    ds_add_u32 v7, v40 offset:8
    s_mov_b64 exec, -1
    s_cmp_eq_u32 s28, 0
    s_cbranch_scc0 L_kidle
    s_mov_b32 s59, 0
L_lspin_3:
    ds_read_b32 v6, v7 offset:8
    s_waitcnt lgkmcnt(0)
    v_readfirstlane_b32 s31, v6
    s_nop 0
    s_cmp_ge_u32 s31, 4
    s_cbranch_scc1 L_lspin_3_x
    s_add_u32 s59, s59, 1
    s_cmp_gt_u32 s59, 1048576
    s_cbranch_scc1 L_lspin_3_x
    s_sleep 1
    s_branch L_lspin_3
L_lspin_3_x:
    ds_read_b128 v[44:47], v7 offset:16
    v_add_u32 v5, 155136, v4
    s_mul_i32 s57, s2, 640
    s_add_u32 s57, s57, 262144
    v_mov_b32 v1, s99
    v_mov_b32 v48, v41
    v_mov_b32 v50, v41
    s_waitcnt lgkmcnt(0)
    v_add_f32 v44, v44, v45
    v_add_f32 v46, v46, v47
    v_add_f32 v49, v44, v46
    v_add_f32 v51, v44, v46
    v_mov_b32 v50, v49
    v_mov_b32 v49, s98
    v_mov_b32 v51, s98
    s_mov_b32 exec_lo, 0xff
    s_mov_b32 exec_hi, 0
    buffer_store_dwordx4 v[48:51], v4, s[44:47], s57 offen offset:512 sc1
    s_mov_b32 exec_lo, 0xffffffff
    s_mov_b32 exec_hi, 0
    s_barrier
    ds_read_b128 v[48:51], v5 offset:0
    ds_read_b128 v[52:55], v5 offset:512
    ds_read_b128 v[56:59], v5 offset:1024
    ds_read_b128 v[60:63], v5 offset:1536
    s_waitcnt lgkmcnt(2)
    v_pk_add_f32 v[48:49], v[48:49], v[52:53]
    v_pk_add_f32 v[50:51], v[50:51], v[54:55]
    s_waitcnt lgkmcnt(0)
    v_pk_add_f32 v[56:57], v[56:57], v[60:61]
    v_pk_add_f32 v[58:59], v[58:59], v[62:63]
    v_pk_add_f32 v[48:49], v[48:49], v[56:57]
    v_pk_add_f32 v[50:51], v[50:51], v[58:59]
    v_and_or_b32 v48, v48, s100, v1
    v_and_or_b32 v49, v49, s100, v1
    v_and_or_b32 v50, v50, s100, v1
    v_and_or_b32 v51, v51, s100, v1
    buffer_store_dwordx4 v[48:51], v4, s[44:47], s57 offen sc1
    s_branch L_fin
L_kidle:
    s_barrier
    s_branch L_fin
L_vwave:
    v_and_b32 v5, 1, v3
    v_lshlrev_b32 v5, 4, v5
    v_mov_b32 v6, 0xffff
    v_lshlrev_b32 v5, v5, v6
    v_lshrrev_b32 v6, 1, v3
    v_cmp_eq_u32 s[32:33], 0, v6
    v_cmp_eq_u32 s[34:35], 1, v6
    v_cmp_eq_u32 s[60:61], 2, v6
    v_cmp_eq_u32 s[62:63], 3, v6
    v_cndmask_b32 v8, 0, v5, s[32:33]
    v_cndmask_b32 v9, 0, v5, s[34:35]
    v_cndmask_b32 v10, 0, v5, s[60:61]
    v_cndmask_b32 v11, 0, v5, s[62:63]
    s_waitcnt lgkmcnt(0)
    s_barrier
L_vcommon:
    s_sub_u32 s28, s28, 4
    s_mul_i32 s32, s28, 37888
    v_add_u32 v5, s32, v4
    v_mov_b32 v7, 157184
    s_lshr_b32 s31, s30, 1
    s_mul_i32 s31, s31, 300032
    s_lshl_b32 s57, s29, 20
    s_add_u32 s31, s31, s57
    s_bitcmp1_b32 s30, 0
    s_cselect_b32 s57, 148480, 0
    s_cselect_b32 s56, 3072, 0
    s_add_u32 s56, s56, 148480
    s_add_u32 s31, s31, s57
    s_add_u32 s52, s8, s31
    s_addc_u32 s53, s9, 0
    s_mov_b32 s54, s56
    s_mov_b32 s55, 0x20000
    s_mul_i32 s31, s28, 148
    v_lshl_add_u32 v12, v3, 2, v2
    v_add_lshl_u32 v12, v12, s31, 2
    v_add_u32 v12, 151552, v12
    v_lshlrev_b32 v13, 5, v3
    v_lshl_add_u32 v13, v2, 4, v13
    s_lshl_b32 s31, s28, 9
    s_add_u32 s31, s31, 155136
    v_add_u32 v13, s31, v13
    buffer_load_dwordx4 v[64:67], v5, s[52:55], 0 offen offset:0 nt
    buffer_load_dwordx4 v[68:71], v5, s[52:55], 0 offen offset:1024 nt
    buffer_load_dwordx4 v[72:75], v5, s[52:55], 0 offen offset:2048 nt
    buffer_load_dwordx4 v[76:79], v5, s[52:55], 0 offen offset:3072 nt
    s_mov_b32 s42, 4096
    buffer_load_dwordx4 v[80:83], v5, s[52:55], s42 offen offset:0 nt
    buffer_load_dwordx4 v[84:87], v5, s[52:55], s42 offen offset:1024 nt
    buffer_load_dwordx4 v[88:91], v5, s[52:55], s42 offen offset:2048 nt
    buffer_load_dwordx4 v[92:95], v5, s[52:55], s42 offen offset:3072 nt
    s_mov_b32 s42, 8192
    buffer_load_dwordx4 v[96:99], v5, s[52:55], s42 offen offset:0 nt
    buffer_load_dwordx4 v[100:103], v5, s[52:55], s42 offen offset:1024 nt
    buffer_load_dwordx4 v[104:107], v5, s[52:55], s42 offen offset:2048 nt
    buffer_load_dwordx4 v[108:111], v5, s[52:55], s42 offen offset:3072 nt
    s_mov_b32 s42, 12288
    buffer_load_dwordx4 v[112:115], v5, s[52:55], s42 offen offset:0 nt
    buffer_load_dwordx4 v[116:119], v5, s[52:55], s42 offen offset:1024 nt
    buffer_load_dwordx4 v[120:123], v5, s[52:55], s42 offen offset:2048 nt
    buffer_load_dwordx4 v[124:127], v5, s[52:55], s42 offen offset:3072 nt
    s_mov_b32 s42, 16384
    buffer_load_dwordx4 v[128:131], v5, s[52:55], s42 offen offset:0 nt
    buffer_load_dwordx4 v[132:135], v5, s[52:55], s42 offen offset:1024 nt
    buffer_load_dwordx4 v[136:139], v5, s[52:55], s42 offen offset:2048 nt
    buffer_load_dwordx4 v[140:143], v5, s[52:55], s42 offen offset:3072 nt
    s_mov_b32 s42, 20480
    buffer_load_dwordx4 v[144:147], v5, s[52:55], s42 offen offset:0 nt
    buffer_load_dwordx4 v[148:151], v5, s[52:55], s42 offen offset:1024 nt
    buffer_load_dwordx4 v[152:155], v5, s[52:55], s42 offen offset:2048 nt
    buffer_load_dwordx4 v[156:159], v5, s[52:55], s42 offen offset:3072 nt
    s_mov_b32 s42, 24576
    buffer_load_dwordx4 v[160:163], v5, s[52:55], s42 offen offset:0 nt
    buffer_load_dwordx4 v[164:167], v5, s[52:55], s42 offen offset:1024 nt
    buffer_load_dwordx4 v[168:171], v5, s[52:55], s42 offen offset:2048 nt
    buffer_load_dwordx4 v[172:175], v5, s[52:55], s42 offen offset:3072 nt
    s_mov_b32 s59, 0
L_lspin_4:
    ds_read_b32 v6, v7 offset:8
    s_waitcnt lgkmcnt(0)
    v_readfirstlane_b32 s31, v6
    s_nop 0
    s_cmp_ge_u32 s31, 4
    s_cbranch_scc1 L_lspin_4_x
    s_add_u32 s59, s59, 1
    s_cmp_gt_u32 s59, 1048576
    s_cbranch_scc1 L_lspin_4_x
    s_sleep 1
    s_branch L_lspin_4
L_lspin_4_x:
    ds_read_b32 v16, v12
    ds_read_b32 v17, v12 offset:256
    ds_read_b32 v18, v12 offset:512
    s_mov_b32 s42, 28672
    buffer_load_dwordx4 v[176:179], v5, s[52:55], s42 offen offset:0 nt
    s_waitcnt lgkmcnt(0)
    v_and_b32_dpp v24, v16, v8 row_newbcast:0 row_mask:0xf bank_mask:0xf
    v_and_b32_dpp v25, v16, v9 row_newbcast:0 row_mask:0xf bank_mask:0xf
    v_and_b32_dpp v26, v16, v10 row_newbcast:0 row_mask:0xf bank_mask:0xf
    v_and_b32_dpp v27, v16, v11 row_newbcast:0 row_mask:0xf bank_mask:0xf
    v_and_b32_dpp v28, v16, v8 row_newbcast:1 row_mask:0xf bank_mask:0xf
    v_and_b32_dpp v29, v16, v9 row_newbcast:1 row_mask:0xf bank_mask:0xf
    v_and_b32_dpp v30, v16, v10 row_newbcast:1 row_mask:0xf bank_mask:0xf
    v_and_b32_dpp v31, v16, v11 row_newbcast:1 row_mask:0xf bank_mask:0xf
    s_waitcnt vmcnt(28)
    v_mfma_f32_16x16x32_bf16 v[32:35], v[24:27], v[64:67], 0
    v_and_b32_dpp v24, v16, v8 row_newbcast:2 row_mask:0xf bank_mask:0xf
    v_and_b32_dpp v25, v16, v9 row_newbcast:2 row_mask:0xf bank_mask:0xf
    v_and_b32_dpp v26, v16, v10 row_newbcast:2 row_mask:0xf bank_mask:0xf
    v_and_b32_dpp v27, v16, v11 row_newbcast:2 row_mask:0xf bank_mask:0xf
    s_waitcnt vmcnt(27)
    v_mfma_f32_16x16x32_bf16 v[32:35], v[28:31], v[68:71], v[32:35]
    buffer_load_dwordx4 v[180:183], v5, s[52:55], s42 offen offset:1024 nt
    v_and_b32_dpp v28, v16, v8 row_newbcast:3 row_mask:0xf bank_mask:0xf
    v_and_b32_dpp v29, v16, v9 row_newbcast:3 row_mask:0xf bank_mask:0xf
    v_and_b32_dpp v30, v16, v10 row_newbcast:3 row_mask:0xf bank_mask:0xf
    v_and_b32_dpp v31, v16, v11 row_newbcast:3 row_mask:0xf bank_mask:0xf
    s_waitcnt vmcnt(27)
    v_mfma_f32_16x16x32_bf16 v[32:35], v[24:27], v[72:75], v[32:35]
    v_and_b32_dpp v24, v16, v8 row_newbcast:4 row_mask:0xf bank_mask:0xf
    v_and_b32_dpp v25, v16, v9 row_newbcast:4 row_mask:0xf bank_mask:0xf
    v_and_b32_dpp v26, v16, v10 row_newbcast:4 row_mask:0xf bank_mask:0xf
    v_and_b32_dpp v27, v16, v11 row_newbcast:4 row_mask:0xf bank_mask:0xf
    s_waitcnt vmcnt(26)
    v_mfma_f32_16x16x32_bf16 v[32:35], v[28:31], v[76:79], v[32:35]
    buffer_load_dwordx4 v[184:187], v5, s[52:55], s42 offen offset:2048 nt
    v_and_b32_dpp v28, v16, v8 row_newbcast:5 row_mask:0xf bank_mask:0xf
    v_and_b32_dpp v29, v16, v9 row_newbcast:5 row_mask:0xf bank_mask:0xf
    v_and_b32_dpp v30, v16, v10 row_newbcast:5 row_mask:0xf bank_mask:0xf
    v_and_b32_dpp v31, v16, v11 row_newbcast:5 row_mask:0xf bank_mask:0xf
    s_waitcnt vmcnt(26)
    v_mfma_f32_16x16x32_bf16 v[32:35], v[24:27], v[80:83], v[32:35]
    v_and_b32_dpp v24, v16, v8 row_newbcast:6 row_mask:0xf bank_mask:0xf
    v_and_b32_dpp v25, v16, v9 row_newbcast:6 row_mask:0xf bank_mask:0xf
    v_and_b32_dpp v26, v16, v10 row_newbcast:6 row_mask:0xf bank_mask:0xf
    v_and_b32_dpp v27, v16, v11 row_newbcast:6 row_mask:0xf bank_mask:0xf
    s_waitcnt vmcnt(25)
    v_mfma_f32_16x16x32_bf16 v[32:35], v[28:31], v[84:87], v[32:35]
    buffer_load_dwordx4 v[188:191], v5, s[52:55], s42 offen offset:3072 nt
    v_and_b32_dpp v28, v16, v8 row_newbcast:7 row_mask:0xf bank_mask:0xf
    v_and_b32_dpp v29, v16, v9 row_newbcast:7 row_mask:0xf bank_mask:0xf
    v_and_b32_dpp v30, v16, v10 row_newbcast:7 row_mask:0xf bank_mask:0xf
    v_and_b32_dpp v31, v16, v11 row_newbcast:7 row_mask:0xf bank_mask:0xf
    s_waitcnt vmcnt(25)
    v_mfma_f32_16x16x32_bf16 v[32:35], v[24:27], v[88:91], v[32:35]
    v_and_b32_dpp v24, v16, v8 row_newbcast:8 row_mask:0xf bank_mask:0xf
    v_and_b32_dpp v25, v16, v9 row_newbcast:8 row_mask:0xf bank_mask:0xf
    v_and_b32_dpp v26, v16, v10 row_newbcast:8 row_mask:0xf bank_mask:0xf
    v_and_b32_dpp v27, v16, v11 row_newbcast:8 row_mask:0xf bank_mask:0xf
    s_waitcnt vmcnt(24)
    v_mfma_f32_16x16x32_bf16 v[32:35], v[28:31], v[92:95], v[32:35]
    s_mov_b32 s42, 32768
    buffer_load_dwordx4 v[192:195], v5, s[52:55], s42 offen offset:0 nt
    v_and_b32_dpp v28, v16, v8 row_newbcast:9 row_mask:0xf bank_mask:0xf
    v_and_b32_dpp v29, v16, v9 row_newbcast:9 row_mask:0xf bank_mask:0xf
    v_and_b32_dpp v30, v16, v10 row_newbcast:9 row_mask:0xf bank_mask:0xf
    v_and_b32_dpp v31, v16, v11 row_newbcast:9 row_mask:0xf bank_mask:0xf
    s_waitcnt vmcnt(24)
    v_mfma_f32_16x16x32_bf16 v[32:35], v[24:27], v[96:99], v[32:35]
    v_and_b32_dpp v24, v16, v8 row_newbcast:10 row_mask:0xf bank_mask:0xf
    v_and_b32_dpp v25, v16, v9 row_newbcast:10 row_mask:0xf bank_mask:0xf
    v_and_b32_dpp v26, v16, v10 row_newbcast:10 row_mask:0xf bank_mask:0xf
    v_and_b32_dpp v27, v16, v11 row_newbcast:10 row_mask:0xf bank_mask:0xf
    s_waitcnt vmcnt(23)
    v_mfma_f32_16x16x32_bf16 v[32:35], v[28:31], v[100:103], v[32:35]
    buffer_load_dwordx4 v[196:199], v5, s[52:55], s42 offen offset:1024 nt
    v_and_b32_dpp v28, v16, v8 row_newbcast:11 row_mask:0xf bank_mask:0xf
    v_and_b32_dpp v29, v16, v9 row_newbcast:11 row_mask:0xf bank_mask:0xf
    v_and_b32_dpp v30, v16, v10 row_newbcast:11 row_mask:0xf bank_mask:0xf
    v_and_b32_dpp v31, v16, v11 row_newbcast:11 row_mask:0xf bank_mask:0xf
    s_waitcnt vmcnt(23)
    v_mfma_f32_16x16x32_bf16 v[32:35], v[24:27], v[104:107], v[32:35]
    v_and_b32_dpp v24, v16, v8 row_newbcast:12 row_mask:0xf bank_mask:0xf
    v_and_b32_dpp v25, v16, v9 row_newbcast:12 row_mask:0xf bank_mask:0xf
    v_and_b32_dpp v26, v16, v10 row_newbcast:12 row_mask:0xf bank_mask:0xf
    v_and_b32_dpp v27, v16, v11 row_newbcast:12 row_mask:0xf bank_mask:0xf
    s_waitcnt vmcnt(22)
    v_mfma_f32_16x16x32_bf16 v[32:35], v[28:31], v[108:111], v[32:35]
    buffer_load_dwordx4 v[200:203], v5, s[52:55], s42 offen offset:2048 nt
    v_and_b32_dpp v28, v16, v8 row_newbcast:13 row_mask:0xf bank_mask:0xf
    v_and_b32_dpp v29, v16, v9 row_newbcast:13 row_mask:0xf bank_mask:0xf
    v_and_b32_dpp v30, v16, v10 row_newbcast:13 row_mask:0xf bank_mask:0xf
    v_and_b32_dpp v31, v16, v11 row_newbcast:13 row_mask:0xf bank_mask:0xf
    s_waitcnt vmcnt(22)
    v_mfma_f32_16x16x32_bf16 v[32:35], v[24:27], v[112:115], v[32:35]
    v_and_b32_dpp v24, v16, v8 row_newbcast:14 row_mask:0xf bank_mask:0xf
    v_and_b32_dpp v25, v16, v9 row_newbcast:14 row_mask:0xf bank_mask:0xf
    v_and_b32_dpp v26, v16, v10 row_newbcast:14 row_mask:0xf bank_mask:0xf
    v_and_b32_dpp v27, v16, v11 row_newbcast:14 row_mask:0xf bank_mask:0xf
    s_waitcnt vmcnt(21)
    v_mfma_f32_16x16x32_bf16 v[32:35], v[28:31], v[116:119], v[32:35]
    buffer_load_dwordx4 v[204:207], v5, s[52:55], s42 offen offset:3072 nt
    v_and_b32_dpp v28, v16, v8 row_newbcast:15 row_mask:0xf bank_mask:0xf
    v_and_b32_dpp v29, v16, v9 row_newbcast:15 row_mask:0xf bank_mask:0xf
    v_and_b32_dpp v30, v16, v10 row_newbcast:15 row_mask:0xf bank_mask:0xf
    v_and_b32_dpp v31, v16, v11 row_newbcast:15 row_mask:0xf bank_mask:0xf
    s_waitcnt vmcnt(21)
    v_mfma_f32_16x16x32_bf16 v[32:35], v[24:27], v[120:123], v[32:35]
    v_and_b32_dpp v24, v17, v8 row_newbcast:0 row_mask:0xf bank_mask:0xf
    v_and_b32_dpp v25, v17, v9 row_newbcast:0 row_mask:0xf bank_mask:0xf
    v_and_b32_dpp v26, v17, v10 row_newbcast:0 row_mask:0xf bank_mask:0xf
    v_and_b32_dpp v27, v17, v11 row_newbcast:0 row_mask:0xf bank_mask:0xf
    s_waitcnt vmcnt(20)
    v_mfma_f32_16x16x32_bf16 v[32:35], v[28:31], v[124:127], v[32:35]
    s_mov_b32 s42, 36864
    buffer_load_dwordx4 v[208:211], v5, s[52:55], s42 offen offset:0 nt
    v_and_b32_dpp v28, v17, v8 row_newbcast:1 row_mask:0xf bank_mask:0xf
    v_and_b32_dpp v29, v17, v9 row_newbcast:1 row_mask:0xf bank_mask:0xf
    v_and_b32_dpp v30, v17, v10 row_newbcast:1 row_mask:0xf bank_mask:0xf
    v_and_b32_dpp v31, v17, v11 row_newbcast:1 row_mask:0xf bank_mask:0xf
    s_waitcnt vmcnt(20)
    v_mfma_f32_16x16x32_bf16 v[32:35], v[24:27], v[128:131], v[32:35]
    v_and_b32_dpp v24, v17, v8 row_newbcast:2 row_mask:0xf bank_mask:0xf
    v_and_b32_dpp v25, v17, v9 row_newbcast:2 row_mask:0xf bank_mask:0xf
    v_and_b32_dpp v26, v17, v10 row_newbcast:2 row_mask:0xf bank_mask:0xf
    v_and_b32_dpp v27, v17, v11 row_newbcast:2 row_mask:0xf bank_mask:0xf
    s_waitcnt vmcnt(19)
    v_mfma_f32_16x16x32_bf16 v[32:35], v[28:31], v[132:135], v[32:35]
    v_and_b32_dpp v28, v17, v8 row_newbcast:3 row_mask:0xf bank_mask:0xf
    v_and_b32_dpp v29, v17, v9 row_newbcast:3 row_mask:0xf bank_mask:0xf
    v_and_b32_dpp v30, v17, v10 row_newbcast:3 row_mask:0xf bank_mask:0xf
    v_and_b32_dpp v31, v17, v11 row_newbcast:3 row_mask:0xf bank_mask:0xf
    s_waitcnt vmcnt(18)
    v_mfma_f32_16x16x32_bf16 v[32:35], v[24:27], v[136:139], v[32:35]
    v_and_b32_dpp v24, v17, v8 row_newbcast:4 row_mask:0xf bank_mask:0xf
    v_and_b32_dpp v25, v17, v9 row_newbcast:4 row_mask:0xf bank_mask:0xf
    v_and_b32_dpp v26, v17, v10 row_newbcast:4 row_mask:0xf bank_mask:0xf
    v_and_b32_dpp v27, v17, v11 row_newbcast:4 row_mask:0xf bank_mask:0xf
    s_waitcnt vmcnt(17)
    v_mfma_f32_16x16x32_bf16 v[32:35], v[28:31], v[140:143], v[32:35]
    v_and_b32_dpp v28, v17, v8 row_newbcast:5 row_mask:0xf bank_mask:0xf
    v_and_b32_dpp v29, v17, v9 row_newbcast:5 row_mask:0xf bank_mask:0xf
    v_and_b32_dpp v30, v17, v10 row_newbcast:5 row_mask:0xf bank_mask:0xf
    v_and_b32_dpp v31, v17, v11 row_newbcast:5 row_mask:0xf bank_mask:0xf
    s_waitcnt vmcnt(16)
    v_mfma_f32_16x16x32_bf16 v[32:35], v[24:27], v[144:147], v[32:35]
    v_and_b32_dpp v24, v17, v8 row_newbcast:6 row_mask:0xf bank_mask:0xf
    v_and_b32_dpp v25, v17, v9 row_newbcast:6 row_mask:0xf bank_mask:0xf
    v_and_b32_dpp v26, v17, v10 row_newbcast:6 row_mask:0xf bank_mask:0xf
    v_and_b32_dpp v27, v17, v11 row_newbcast:6 row_mask:0xf bank_mask:0xf
    s_waitcnt vmcnt(15)
    v_mfma_f32_16x16x32_bf16 v[32:35], v[28:31], v[148:151], v[32:35]
    v_and_b32_dpp v28, v17, v8 row_newbcast:7 row_mask:0xf bank_mask:0xf
    v_and_b32_dpp v29, v17, v9 row_newbcast:7 row_mask:0xf bank_mask:0xf
    v_and_b32_dpp v30, v17, v10 row_newbcast:7 row_mask:0xf bank_mask:0xf
    v_and_b32_dpp v31, v17, v11 row_newbcast:7 row_mask:0xf bank_mask:0xf
    s_waitcnt vmcnt(14)
    v_mfma_f32_16x16x32_bf16 v[32:35], v[24:27], v[152:155], v[32:35]
    v_and_b32_dpp v24, v17, v8 row_newbcast:8 row_mask:0xf bank_mask:0xf
    v_and_b32_dpp v25, v17, v9 row_newbcast:8 row_mask:0xf bank_mask:0xf
    v_and_b32_dpp v26, v17, v10 row_newbcast:8 row_mask:0xf bank_mask:0xf
    v_and_b32_dpp v27, v17, v11 row_newbcast:8 row_mask:0xf bank_mask:0xf
    s_waitcnt vmcnt(13)
    v_mfma_f32_16x16x32_bf16 v[32:35], v[28:31], v[156:159], v[32:35]
    v_and_b32_dpp v28, v17, v8 row_newbcast:9 row_mask:0xf bank_mask:0xf
    v_and_b32_dpp v29, v17, v9 row_newbcast:9 row_mask:0xf bank_mask:0xf
    v_and_b32_dpp v30, v17, v10 row_newbcast:9 row_mask:0xf bank_mask:0xf
    v_and_b32_dpp v31, v17, v11 row_newbcast:9 row_mask:0xf bank_mask:0xf
    s_waitcnt vmcnt(12)
    v_mfma_f32_16x16x32_bf16 v[32:35], v[24:27], v[160:163], v[32:35]
    v_and_b32_dpp v24, v17, v8 row_newbcast:10 row_mask:0xf bank_mask:0xf
    v_and_b32_dpp v25, v17, v9 row_newbcast:10 row_mask:0xf bank_mask:0xf
    v_and_b32_dpp v26, v17, v10 row_newbcast:10 row_mask:0xf bank_mask:0xf
    v_and_b32_dpp v27, v17, v11 row_newbcast:10 row_mask:0xf bank_mask:0xf
    s_waitcnt vmcnt(11)
    v_mfma_f32_16x16x32_bf16 v[32:35], v[28:31], v[164:167], v[32:35]
    v_and_b32_dpp v28, v17, v8 row_newbcast:11 row_mask:0xf bank_mask:0xf
    v_and_b32_dpp v29, v17, v9 row_newbcast:11 row_mask:0xf bank_mask:0xf
    v_and_b32_dpp v30, v17, v10 row_newbcast:11 row_mask:0xf bank_mask:0xf
    v_and_b32_dpp v31, v17, v11 row_newbcast:11 row_mask:0xf bank_mask:0xf
    s_waitcnt vmcnt(10)
    v_mfma_f32_16x16x32_bf16 v[32:35], v[24:27], v[168:171], v[32:35]
    v_and_b32_dpp v24, v17, v8 row_newbcast:12 row_mask:0xf bank_mask:0xf
    v_and_b32_dpp v25, v17, v9 row_newbcast:12 row_mask:0xf bank_mask:0xf
    v_and_b32_dpp v26, v17, v10 row_newbcast:12 row_mask:0xf bank_mask:0xf
    v_and_b32_dpp v27, v17, v11 row_newbcast:12 row_mask:0xf bank_mask:0xf
    s_waitcnt vmcnt(9)
    v_mfma_f32_16x16x32_bf16 v[32:35], v[28:31], v[172:175], v[32:35]
    v_and_b32_dpp v28, v17, v8 row_newbcast:13 row_mask:0xf bank_mask:0xf
    v_and_b32_dpp v29, v17, v9 row_newbcast:13 row_mask:0xf bank_mask:0xf
    v_and_b32_dpp v30, v17, v10 row_newbcast:13 row_mask:0xf bank_mask:0xf
    v_and_b32_dpp v31, v17, v11 row_newbcast:13 row_mask:0xf bank_mask:0xf
    s_waitcnt vmcnt(8)
    v_mfma_f32_16x16x32_bf16 v[32:35], v[24:27], v[176:179], v[32:35]
    v_and_b32_dpp v24, v17, v8 row_newbcast:14 row_mask:0xf bank_mask:0xf
    v_and_b32_dpp v25, v17, v9 row_newbcast:14 row_mask:0xf bank_mask:0xf
    v_and_b32_dpp v26, v17, v10 row_newbcast:14 row_mask:0xf bank_mask:0xf
    v_and_b32_dpp v27, v17, v11 row_newbcast:14 row_mask:0xf bank_mask:0xf
    s_waitcnt vmcnt(7)
    v_mfma_f32_16x16x32_bf16 v[32:35], v[28:31], v[180:183], v[32:35]
    v_and_b32_dpp v28, v17, v8 row_newbcast:15 row_mask:0xf bank_mask:0xf
    v_and_b32_dpp v29, v17, v9 row_newbcast:15 row_mask:0xf bank_mask:0xf
    v_and_b32_dpp v30, v17, v10 row_newbcast:15 row_mask:0xf bank_mask:0xf
    v_and_b32_dpp v31, v17, v11 row_newbcast:15 row_mask:0xf bank_mask:0xf
    s_waitcnt vmcnt(6)
    v_mfma_f32_16x16x32_bf16 v[32:35], v[24:27], v[184:187], v[32:35]
    v_and_b32_dpp v24, v18, v8 row_newbcast:0 row_mask:0xf bank_mask:0xf
    v_and_b32_dpp v25, v18, v9 row_newbcast:0 row_mask:0xf bank_mask:0xf
    v_and_b32_dpp v26, v18, v10 row_newbcast:0 row_mask:0xf bank_mask:0xf
    v_and_b32_dpp v27, v18, v11 row_newbcast:0 row_mask:0xf bank_mask:0xf
    s_waitcnt vmcnt(5)
    v_mfma_f32_16x16x32_bf16 v[32:35], v[28:31], v[188:191], v[32:35]
    v_and_b32_dpp v28, v18, v8 row_newbcast:1 row_mask:0xf bank_mask:0xf
    v_and_b32_dpp v29, v18, v9 row_newbcast:1 row_mask:0xf bank_mask:0xf
    v_and_b32_dpp v30, v18, v10 row_newbcast:1 row_mask:0xf bank_mask:0xf
    v_and_b32_dpp v31, v18, v11 row_newbcast:1 row_mask:0xf bank_mask:0xf
    s_waitcnt vmcnt(4)
    v_mfma_f32_16x16x32_bf16 v[32:35], v[24:27], v[192:195], v[32:35]
    v_and_b32_dpp v24, v18, v8 row_newbcast:2 row_mask:0xf bank_mask:0xf
    v_and_b32_dpp v25, v18, v9 row_newbcast:2 row_mask:0xf bank_mask:0xf
    v_and_b32_dpp v26, v18, v10 row_newbcast:2 row_mask:0xf bank_mask:0xf
    v_and_b32_dpp v27, v18, v11 row_newbcast:2 row_mask:0xf bank_mask:0xf
    s_waitcnt vmcnt(3)
    v_mfma_f32_16x16x32_bf16 v[32:35], v[28:31], v[196:199], v[32:35]
    v_and_b32_dpp v28, v18, v8 row_newbcast:3 row_mask:0xf bank_mask:0xf
    v_and_b32_dpp v29, v18, v9 row_newbcast:3 row_mask:0xf bank_mask:0xf
    v_and_b32_dpp v30, v18, v10 row_newbcast:3 row_mask:0xf bank_mask:0xf
    v_and_b32_dpp v31, v18, v11 row_newbcast:3 row_mask:0xf bank_mask:0xf
    s_waitcnt vmcnt(2)
    v_mfma_f32_16x16x32_bf16 v[32:35], v[24:27], v[200:203], v[32:35]
    v_and_b32_dpp v24, v18, v8 row_newbcast:4 row_mask:0xf bank_mask:0xf
    v_and_b32_dpp v25, v18, v9 row_newbcast:4 row_mask:0xf bank_mask:0xf
    v_and_b32_dpp v26, v18, v10 row_newbcast:4 row_mask:0xf bank_mask:0xf
    v_and_b32_dpp v27, v18, v11 row_newbcast:4 row_mask:0xf bank_mask:0xf
    s_waitcnt vmcnt(1)
    v_mfma_f32_16x16x32_bf16 v[32:35], v[28:31], v[204:207], v[32:35]
    s_nop 1
    s_waitcnt vmcnt(0)
    v_mfma_f32_16x16x32_bf16 v[32:35], v[24:27], v[208:211], v[32:35]
    v_mov_b32 v5, v13
    s_mov_b32 exec_lo, 0xffffffff
    s_mov_b32 exec_hi, 0
    s_nop 6
    ds_write_b128 v5, v[32:35]
    s_waitcnt lgkmcnt(0)
    s_barrier
    s_branch L_fin
    .p2align 6
L_tail:
    s_lshr_b32 s57, s29, 2
    s_lshl_b32 s31, s57, 19
    s_lshl_b32 s32, s28, 16
    s_add_u32 s31, s31, s32
    s_and_b32 s32, s29, 3
    s_lshl_b32 s32, s32, 8
    s_add_u32 s31, s31, s32
    s_sub_u32 s32, 0x400000, s31
    v_lshlrev_b32 v5, 1, v2
    v_xor_b32 v5, v5, v3
    v_lshlrev_b32 v6, 10, v2
    v_lshl_add_u32 v214, v5, 4, v6
    v_xor_b32 v215, 0x80, v214
    s_lshl_b32 s40, s28, 14
    s_waitcnt lgkmcnt(0)
    s_add_u32 s52, s12, s31
    s_addc_u32 s53, s13, 0
    s_mov_b32 s54, s32
    s_mov_b32 s55, 0x20000
    s_add_u32 s96, s26, 598016
    s_addc_u32 s97, s27, 0
    s_load_dword s98, s[96:97], 0
    s_mov_b32 m0, s40
    s_mov_b32 s31, 0
    buffer_load_dwordx4 v214, s[52:55], s31 offen  lds
    s_add_u32 m0, s40, 1024
    s_mov_b32 s31, 4096
    buffer_load_dwordx4 v214, s[52:55], s31 offen  lds
    s_add_u32 m0, s40, 2048
    s_mov_b32 s31, 16384
    buffer_load_dwordx4 v215, s[52:55], s31 offen  lds
    s_add_u32 m0, s40, 3072
    s_mov_b32 s31, 20480
    buffer_load_dwordx4 v215, s[52:55], s31 offen  lds
    s_cmp_eq_u32 s28, 1
    s_cbranch_scc0 L_nopft
    s_getpc_b64 s[32:33]
L_pct:
    s_sub_u32 s32, s32, L_pct - sequential_preLN__mha_block_cached__geglu_ffn__decode_kernel
    s_subb_u32 s33, s33, 0
    v_and_b32 v5, 3, v0
    v_lshlrev_b32 v5, 5, v5
    v_add_lshl_u32 v5, v5, s29, 7
    v_min_u32 v6, L_end - sequential_preLN__mha_block_cached__geglu_ffn__decode_kernel, v5
    global_load_dword v254, v6, s[32:33]
L_nopft:
    s_mov_b32 s36, s4
    s_mov_b32 s37, s5
    s_mov_b32 s38, 1024
    s_mov_b32 s39, 0x20000
    s_mov_b32 s44, s26
    s_mov_b32 s45, s27
    s_mov_b32 s46, 602112
    s_mov_b32 s47, 0x20000
    s_getreg_b32 s56, hwreg(HW_REG_XCC_ID, 0, 4)
    v_bfe_u32 v5, v0, 2, 2
    v_and_b32 v6, 1, v2
    v_lshlrev_b32 v7, 2, v6
    v_add_lshl_u32 v7, v7, v5, 5
    v_and_b32 v12, 3, v0
    v_lshlrev_b32 v12, 3, v12
    v_add_u32 v12, s40, v12
    v_lshl_add_u32 v13, v2, 3, v5
    v_lshl_add_u32 v218, v13, 8, v12
    v_add_u32 v218, v218, v7
    v_xor_b32 v219, 32, v218
    v_xor_b32 v220, 64, v218
    v_xor_b32 v221, 96, v218
    v_xor_b32 v222, 128, v218
    v_xor_b32 v223, 160, v218
    v_xor_b32 v224, 192, v218
    v_xor_b32 v225, 224, v218
    v_mul_u32_u24 v13, 0xc0, v13
    v_add_u32 v13, v13, v12
    v_lshl_add_u32 v226, v6, 5, v13
    v_xor_b32 v6, 1, v6
    v_lshl_add_u32 v227, v6, 5, v13
    v_min_u32 v6, 2, v2
    v_lshl_add_u32 v13, v6, 3, v5
    v_lshl_add_u32 v244, v13, 7, v12
    v_and_b32 v6, 1, v6
    v_lshrrev_b32 v7, 1, v5
    v_lshl_add_u32 v7, v6, 1, v7
    v_lshl_add_u32 v244, v7, 5, v244
    v_xor_b32 v245, 32, v244
    v_xor_b32 v246, 64, v244
    v_xor_b32 v247, 96, v244
    s_waitcnt lgkmcnt(0)
    s_add_u32 s101, s98, 1
    s_mul_i32 s98, s98, 0x9e3779b1
    s_and_b32 s99, s101, 0xff
    s_add_u32 s98, s98, 0x7f4a7c15
    s_mov_b32 s100, 0xffffff00
    v_mov_b32 v1, s99
    v_mov_b32 v252, 0
    s_cmp_eq_u32 s28, 2
    s_cbranch_scc0 L_noxcc
    v_mov_b32 v12, s56
    v_mov_b32 v13, s98
    v_mov_b32 v14, s56
    v_mov_b32 v15, s98
    s_lshl_b32 s33, s29, 7
    s_add_u32 s33, s33, 589824
    s_mov_b32 exec_lo, 0xff
    s_mov_b32 exec_hi, 0
    buffer_store_dwordx4 v[12:15], v4, s[44:47], s33 offen sc1
    s_mov_b64 exec, -1
L_noxcc:
    s_waitcnt vmcnt(3)
    s_add_u32 m0, s40, 4096
    s_mov_b32 s31, 32768
    buffer_load_dwordx4 v214, s[52:55], s31 offen  lds
    s_waitcnt vmcnt(3)
    s_add_u32 m0, s40, 5120
    s_mov_b32 s31, 36864
    buffer_load_dwordx4 v214, s[52:55], s31 offen  lds
    s_waitcnt vmcnt(3)
    s_add_u32 m0, s40, 6144
    s_mov_b32 s31, 49152
    buffer_load_dwordx4 v215, s[52:55], s31 offen  lds
    s_waitcnt vmcnt(3)
    s_add_u32 m0, s40, 7168
    s_mov_b32 s31, 53248
    buffer_load_dwordx4 v215, s[52:55], s31 offen  lds
    v_add_u32 v5, 0, v0
    v_mul_u32_u24 v6, 0xaaab, v5
    v_lshrrev_b32 v6, 19, v6
    v_mul_u32_u24 v7, 12, v6
    v_sub_u32 v5, v5, v7
    v_bfe_u32 v7, v6, 3, 1
    v_lshlrev_b32 v7, 1, v7
    v_xor_b32 v5, v5, v7
    v_cmp_gt_u32 vcc, 6, v5
    v_mov_b32 v12, s18
    v_mov_b32 v13, s19
    v_mov_b32 v14, s16
    v_mov_b32 v15, s17
    v_cndmask_b32 v12, v12, v14, vcc
    v_cndmask_b32 v13, v13, v15, vcc
    v_subrev_u32 v7, 6, v5
    v_cndmask_b32 v5, v7, v5, vcc
    s_mul_i32 s31, s29, 6
    v_add_u32 v5, s31, v5
    v_min_u32 v5, 0xab, v5
    v_and_b32 v7, 7, v6
    v_lshlrev_b32 v6, 1, v6
    v_sub_u32 v6, v6, v7
    s_lshl_b32 s31, s28, 6
    v_add_u32 v6, s31, v6
    v_mul_u32_u24 v6, 0xac0, v6
    v_lshl_add_u32 v6, v5, 4, v6
    v_mov_b32 v7, 0
    v_lshl_add_u64 v[208:209], v[12:13], 0, v[6:7]
    v_add_u32 v5, 64, v0
    v_mul_u32_u24 v6, 0xaaab, v5
    v_lshrrev_b32 v6, 19, v6
    v_mul_u32_u24 v7, 12, v6
    v_sub_u32 v5, v5, v7
    v_bfe_u32 v7, v6, 3, 1
    v_lshlrev_b32 v7, 1, v7
    v_xor_b32 v5, v5, v7
    v_cmp_gt_u32 vcc, 6, v5
    v_mov_b32 v12, s18
    v_mov_b32 v13, s19
    v_mov_b32 v14, s16
    v_mov_b32 v15, s17
    v_cndmask_b32 v12, v12, v14, vcc
    v_cndmask_b32 v13, v13, v15, vcc
    v_subrev_u32 v7, 6, v5
    v_cndmask_b32 v5, v7, v5, vcc
    s_mul_i32 s31, s29, 6
    v_add_u32 v5, s31, v5
    v_min_u32 v5, 0xab, v5
    v_and_b32 v7, 7, v6
    v_lshlrev_b32 v6, 1, v6
    v_sub_u32 v6, v6, v7
    s_lshl_b32 s31, s28, 6
    v_add_u32 v6, s31, v6
    v_mul_u32_u24 v6, 0xac0, v6
    v_lshl_add_u32 v6, v5, 4, v6
    v_mov_b32 v7, 0
    v_lshl_add_u64 v[210:211], v[12:13], 0, v[6:7]
    v_add_u32 v5, 128, v0
    v_mul_u32_u24 v6, 0xaaab, v5
    v_lshrrev_b32 v6, 19, v6
    v_mul_u32_u24 v7, 12, v6
    v_sub_u32 v5, v5, v7
    v_bfe_u32 v7, v6, 3, 1
    v_lshlrev_b32 v7, 1, v7
    v_xor_b32 v5, v5, v7
    v_cmp_gt_u32 vcc, 6, v5
    v_mov_b32 v12, s18
    v_mov_b32 v13, s19
    v_mov_b32 v14, s16
    v_mov_b32 v15, s17
    v_cndmask_b32 v12, v12, v14, vcc
    v_cndmask_b32 v13, v13, v15, vcc
    v_subrev_u32 v7, 6, v5
    v_cndmask_b32 v5, v7, v5, vcc
    s_mul_i32 s31, s29, 6
    v_add_u32 v5, s31, v5
    v_min_u32 v5, 0xab, v5
    v_and_b32 v7, 7, v6
    v_lshlrev_b32 v6, 1, v6
    v_sub_u32 v6, v6, v7
    s_lshl_b32 s31, s28, 6
    v_add_u32 v6, s31, v6
    v_mul_u32_u24 v6, 0xac0, v6
    v_lshl_add_u32 v6, v5, 4, v6
    v_mov_b32 v7, 0
    v_lshl_add_u64 v[212:213], v[12:13], 0, v[6:7]
    s_mov_b32 s34, 88064
    s_mov_b32 s35, 0
    s_mov_b32 s42, -66048
    s_mov_b32 s43, -1
    s_waitcnt vmcnt(3)
    s_add_u32 m0, s40, 8192
    s_mov_b32 s31, 8192
    buffer_load_dwordx4 v214, s[52:55], s31 offen  lds
    s_waitcnt vmcnt(3)
    s_add_u32 m0, s40, 9216
    s_mov_b32 s31, 12288
    buffer_load_dwordx4 v214, s[52:55], s31 offen  lds
    s_waitcnt vmcnt(3)
    s_add_u32 m0, s40, 10240
    s_mov_b32 s31, 24576
    buffer_load_dwordx4 v215, s[52:55], s31 offen  lds
    s_waitcnt vmcnt(3)
    s_add_u32 m0, s40, 11264
    s_mov_b32 s31, 28672
    buffer_load_dwordx4 v215, s[52:55], s31 offen  lds
    s_mov_b32 s60, s20
    s_mov_b32 s61, s21
    s_mov_b32 s62, 1409024
    s_mov_b32 s63, 0x20000
    v_lshrrev_b32 v5, 3, v0
    v_bfe_u32 v6, v0, 4, 1
    v_lshlrev_b32 v6, 1, v6
    v_and_b32 v7, 7, v0
    v_xor_b32 v6, v6, v7
    v_lshlrev_b32 v6, 4, v6
    v_lshl_add_u32 v6, v5, 10, v6
    s_lshl_b32 s31, s28, 7
    v_add_u32 v216, s31, v6
    v_xor_b32 v217, 64, v216
    s_mul_i32 s41, s29, 0xc000
    s_waitcnt vmcnt(3)
    s_add_u32 m0, s40, 12288
    s_mov_b32 s31, 40960
    buffer_load_dwordx4 v214, s[52:55], s31 offen  lds
    s_waitcnt vmcnt(3)
    s_add_u32 m0, s40, 13312
    s_mov_b32 s31, 45056
    buffer_load_dwordx4 v214, s[52:55], s31 offen  lds
    s_waitcnt vmcnt(3)
    s_add_u32 m0, s40, 14336
    s_mov_b32 s31, 57344
    buffer_load_dwordx4 v215, s[52:55], s31 offen  lds
    s_waitcnt vmcnt(3)
    s_add_u32 m0, s40, 15360
    s_mov_b32 s31, 61440
    buffer_load_dwordx4 v215, s[52:55], s31 offen  lds
    s_waitcnt vmcnt(3)
    s_waitcnt vmcnt(3)
    ds_read_b64_tr_b16 v[64:65], v218 offset:0
    ds_read_b64_tr_b16 v[66:67], v218 offset:1024
    ds_read_b64_tr_b16 v[68:69], v219 offset:0
    ds_read_b64_tr_b16 v[70:71], v219 offset:1024
    ds_read_b64_tr_b16 v[72:73], v220 offset:0
    ds_read_b64_tr_b16 v[74:75], v220 offset:1024
    ds_read_b64_tr_b16 v[76:77], v221 offset:0
    ds_read_b64_tr_b16 v[78:79], v221 offset:1024
    ds_read_b64_tr_b16 v[80:81], v222 offset:0
    ds_read_b64_tr_b16 v[82:83], v222 offset:1024
    ds_read_b64_tr_b16 v[84:85], v223 offset:0
    ds_read_b64_tr_b16 v[86:87], v223 offset:1024
    ds_read_b64_tr_b16 v[88:89], v224 offset:0
    ds_read_b64_tr_b16 v[90:91], v224 offset:1024
    ds_read_b64_tr_b16 v[92:93], v225 offset:0
    ds_read_b64_tr_b16 v[94:95], v225 offset:1024
    s_cmp_ge_u32 s29, 29
    s_cbranch_scc1 L_no_ffn
    s_waitcnt lgkmcnt(0)
    s_mov_b32 m0, s40
    s_nop 0
    global_load_lds_dwordx4 v[208:209], off
    v_lshl_add_u64 v[208:209], v[208:209], 0, s[34:35]
    s_waitcnt vmcnt(3)
    s_add_u32 m0, s40, 1024
    s_nop 0
    global_load_lds_dwordx4 v[210:211], off
    v_lshl_add_u64 v[210:211], v[210:211], 0, s[34:35]
    s_waitcnt vmcnt(3)
    s_add_u32 m0, s40, 2048
    s_nop 0
    global_load_lds_dwordx4 v[212:213], off
    v_lshl_add_u64 v[212:213], v[212:213], 0, s[34:35]
    s_waitcnt vmcnt(3)
    s_add_u32 m0, s40, 3072
    s_nop 0
    global_load_lds_dwordx4 v[208:209], off
    v_lshl_add_u64 v[208:209], v[208:209], 0, s[42:43]
    s_waitcnt vmcnt(3)
    s_add_u32 m0, s40, 4096
    s_nop 0
    global_load_lds_dwordx4 v[210:211], off
    v_lshl_add_u64 v[210:211], v[210:211], 0, s[42:43]
    s_waitcnt vmcnt(3)
    s_add_u32 m0, s40, 5120
    s_nop 0
    global_load_lds_dwordx4 v[212:213], off
    v_lshl_add_u64 v[212:213], v[212:213], 0, s[42:43]
    s_waitcnt vmcnt(3)
    s_waitcnt vmcnt(3)
    ds_read_b64_tr_b16 v[96:97], v218 offset:8192
    ds_read_b64_tr_b16 v[98:99], v218 offset:9216
    ds_read_b64_tr_b16 v[100:101], v219 offset:8192
    ds_read_b64_tr_b16 v[102:103], v219 offset:9216
    ds_read_b64_tr_b16 v[104:105], v220 offset:8192
    ds_read_b64_tr_b16 v[106:107], v220 offset:9216
    ds_read_b64_tr_b16 v[108:109], v221 offset:8192
    ds_read_b64_tr_b16 v[110:111], v221 offset:9216
    ds_read_b64_tr_b16 v[112:113], v222 offset:8192
    ds_read_b64_tr_b16 v[114:115], v222 offset:9216
    ds_read_b64_tr_b16 v[116:117], v223 offset:8192
    ds_read_b64_tr_b16 v[118:119], v223 offset:9216
    ds_read_b64_tr_b16 v[120:121], v224 offset:8192
    ds_read_b64_tr_b16 v[122:123], v224 offset:9216
    ds_read_b64_tr_b16 v[124:125], v225 offset:8192
    ds_read_b64_tr_b16 v[126:127], v225 offset:9216
    s_waitcnt lgkmcnt(0)
    s_add_u32 m0, s40, 8192
    s_nop 0
    global_load_lds_dwordx4 v[208:209], off
    v_lshl_add_u64 v[208:209], v[208:209], 0, s[34:35]
    s_waitcnt vmcnt(3)
    s_add_u32 m0, s40, 9216
    s_nop 0
    global_load_lds_dwordx4 v[210:211], off
    v_lshl_add_u64 v[210:211], v[210:211], 0, s[34:35]
    s_waitcnt vmcnt(3)
    s_add_u32 m0, s40, 10240
    s_nop 0
    global_load_lds_dwordx4 v[212:213], off
    v_lshl_add_u64 v[212:213], v[212:213], 0, s[34:35]
    s_waitcnt vmcnt(3)
    s_add_u32 m0, s40, 11264
    s_nop 0
    global_load_lds_dwordx4 v[208:209], off
    s_waitcnt vmcnt(3)
    s_add_u32 m0, s40, 12288
    s_nop 0
    global_load_lds_dwordx4 v[210:211], off
    s_waitcnt vmcnt(3)
    s_add_u32 m0, s40, 13312
    s_nop 0
    global_load_lds_dwordx4 v[212:213], off
    s_waitcnt vmcnt(3)
    s_waitcnt vmcnt(3)
    ds_read_b64_tr_b16 v[128:129], v226 offset:0
    ds_read_b64_tr_b16 v[130:131], v226 offset:768
    ds_read_b64_tr_b16 v[132:133], v227 offset:0
    ds_read_b64_tr_b16 v[134:135], v227 offset:768
    ds_read_b64_tr_b16 v[136:137], v226 offset:64
    ds_read_b64_tr_b16 v[138:139], v226 offset:832
    ds_read_b64_tr_b16 v[140:141], v227 offset:64
    ds_read_b64_tr_b16 v[142:143], v227 offset:832
    ds_read_b64_tr_b16 v[144:145], v226 offset:128
    ds_read_b64_tr_b16 v[146:147], v226 offset:896
    ds_read_b64_tr_b16 v[148:149], v227 offset:128
    ds_read_b64_tr_b16 v[150:151], v227 offset:896
    s_waitcnt lgkmcnt(0)
    s_branch L_ffn_go
L_no_ffn:
    s_waitcnt vmcnt(0)
    ds_read_b64_tr_b16 v[96:97], v218 offset:8192
    ds_read_b64_tr_b16 v[98:99], v218 offset:9216
    ds_read_b64_tr_b16 v[100:101], v219 offset:8192
    ds_read_b64_tr_b16 v[102:103], v219 offset:9216
    ds_read_b64_tr_b16 v[104:105], v220 offset:8192
    ds_read_b64_tr_b16 v[106:107], v220 offset:9216
    ds_read_b64_tr_b16 v[108:109], v221 offset:8192
    ds_read_b64_tr_b16 v[110:111], v221 offset:9216
    ds_read_b64_tr_b16 v[112:113], v222 offset:8192
    ds_read_b64_tr_b16 v[114:115], v222 offset:9216
    ds_read_b64_tr_b16 v[116:117], v223 offset:8192
    ds_read_b64_tr_b16 v[118:119], v223 offset:9216
    ds_read_b64_tr_b16 v[120:121], v224 offset:8192
    ds_read_b64_tr_b16 v[122:123], v224 offset:9216
    ds_read_b64_tr_b16 v[124:125], v225 offset:8192
    ds_read_b64_tr_b16 v[126:127], v225 offset:9216
    s_waitcnt lgkmcnt(0)
L_ffn_go:
    s_cmp_eq_u32 s28, 0
    s_cbranch_scc0 L_nox1
    v_and_b32 v6, 31, v0
    v_lshlrev_b32 v6, 7, v6
    s_mov_b32 s31, 589824
    buffer_load_dwordx2 v[18:19], v6, s[44:47], s31 offen
L_nox1:
    s_mov_b32 m0, s40
    s_add_u32 s31, s41, 0
    buffer_load_dwordx4 v216, s[60:63], s31 offen  lds
    s_waitcnt vmcnt(3)
    s_add_u32 m0, s40, 1024
    s_add_u32 s31, s41, 16384
    buffer_load_dwordx4 v217, s[60:63], s31 offen  lds
    s_waitcnt vmcnt(3)
    s_add_u32 m0, s40, 2048
    s_add_u32 s31, s41, 32768
    buffer_load_dwordx4 v216, s[60:63], s31 offen  lds
    s_waitcnt vmcnt(3)
    s_add_u32 m0, s40, 3072
    s_add_u32 s31, s41, 8192
    buffer_load_dwordx4 v216, s[60:63], s31 offen  lds
    s_waitcnt vmcnt(3)
    s_add_u32 m0, s40, 4096
    s_add_u32 s31, s41, 24576
    buffer_load_dwordx4 v217, s[60:63], s31 offen  lds
    s_waitcnt vmcnt(3)
    s_add_u32 m0, s40, 5120
    s_add_u32 s31, s41, 40960
    buffer_load_dwordx4 v216, s[60:63], s31 offen  lds
    s_waitcnt vmcnt(3)
    s_waitcnt vmcnt(3)
    ds_read_b64_tr_b16 v[152:153], v226 offset:8192
    ds_read_b64_tr_b16 v[154:155], v226 offset:8960
    ds_read_b64_tr_b16 v[156:157], v227 offset:8192
    ds_read_b64_tr_b16 v[158:159], v227 offset:8960
    ds_read_b64_tr_b16 v[160:161], v226 offset:8256
    ds_read_b64_tr_b16 v[162:163], v226 offset:9024
    ds_read_b64_tr_b16 v[164:165], v227 offset:8256
    ds_read_b64_tr_b16 v[166:167], v227 offset:9024
    ds_read_b64_tr_b16 v[168:169], v226 offset:8320
    ds_read_b64_tr_b16 v[170:171], v226 offset:9088
    ds_read_b64_tr_b16 v[172:173], v227 offset:8320
    ds_read_b64_tr_b16 v[174:175], v227 offset:9088
    v_mov_b32 v232, 0x3f803f80
    v_mov_b32 v233, 0x3f803f80
    v_mov_b32 v234, 0x3f803f80
    v_mov_b32 v235, 0x3f803f80
    s_lshl_b32 s32, s28, 2
    s_add_u32 s32, s32, 142464
    v_lshl_add_u32 v236, v3, 5, s32
    s_waitcnt lgkmcnt(0)
    v_mfma_f32_16x16x32_bf16 v[208:211], v[232:235], v[128:131], 0
    v_mfma_f32_16x16x32_bf16 v[212:215], v[232:235], v[132:135], 0
    v_mfma_f32_16x16x32_bf16 v[216:219], v[232:235], v[136:139], 0
    v_mfma_f32_16x16x32_bf16 v[220:223], v[232:235], v[140:143], 0
    v_mfma_f32_16x16x32_bf16 v[224:227], v[232:235], v[144:147], 0
    v_mfma_f32_16x16x32_bf16 v[228:231], v[232:235], v[148:151], 0
    v_mfma_f32_16x16x32_bf16 v[208:211], v[232:235], v[152:155], v[208:211]
    v_mfma_f32_16x16x32_bf16 v[212:215], v[232:235], v[156:159], v[212:215]
    v_mfma_f32_16x16x32_bf16 v[216:219], v[232:235], v[160:163], v[216:219]
    v_mfma_f32_16x16x32_bf16 v[220:223], v[232:235], v[164:167], v[220:223]
    v_mfma_f32_16x16x32_bf16 v[224:227], v[232:235], v[168:171], v[224:227]
    v_mfma_f32_16x16x32_bf16 v[228:231], v[232:235], v[172:175], v[228:231]
    s_nop 5
    s_mov_b32 exec_lo, 0xffff
    s_mov_b32 exec_hi, 0
    ds_write2st64_b32 v236, v208, v212 offset0:0 offset1:2
    ds_write2st64_b32 v236, v216, v220 offset0:4 offset1:6
    ds_write2st64_b32 v236, v224, v228 offset0:8 offset1:10
    s_mov_b64 exec, -1
    s_mul_i32 s31, s29, 48
    v_add_u32 v6, s31, v0
    v_cmp_gt_u32 s[34:35], 48, v0
    v_cmp_gt_u32 vcc, 0x560, v6
    s_lshl_b32 s31, s28, 6
    v_add_lshl_u32 v6, v0, s31, 1
    s_and_b64 s[96:97], s[34:35], vcc
    buffer_load_ushort v20, v6, s[36:39], 0 offen
    s_lshl_b32 s32, s29, 11
    s_add_u32 s32, s32, 458752
    s_lshl_b32 s33, s28, 8
    s_add_u32 s32, s32, s33
    v_lshlrev_b32 v6, 2, v0
    buffer_load_dword v17, v6, s[44:47], s32 offen sc1
    s_cmp_eq_u32 s28, 3
    s_cbranch_scc0 L_nowb
    s_lshl_b32 s31, s29, 9
    s_add_u32 s31, s31, 425984
    v_lshlrev_b32 v6, 3, v0
    buffer_load_dword v16, v6, s[44:47], s31 offen sc1
L_nowb:
    s_cmp_eq_u32 s28, 6
    s_cbranch_scc0 L_nolpf
    s_getpc_b64 s[32:33]
L_pcl:
    v_lshlrev_b32 v5, 7, v0
    v_min_u32 v6, L_end - L_pcl, v5
    global_load_dword v254, v6, s[32:33]
L_nolpf:
    s_lshl_b32 s31, s57, 2
    s_lshr_b32 s32, s28, 1
    s_add_u32 s31, s31, s32
    s_mul_i32 s31, s31, 5120
    s_add_u32 s31, s31, 262144
    s_and_b32 s32, s28, 1
    s_lshl_b32 s32, s32, 8
    v_lshl_add_u32 v5, v0, 2, s32
    v_add_u32 v6, 2560, v5
    v_and_b32 v7, 7, v0
    v_min_u32 v7, 6, v7
    v_mul_u32_u24 v7, 640, v7
    buffer_load_dwordx4 v[52:55], v7, s[44:47], s31 offen offset:512 sc1
    buffer_load_dword v42, v5, s[44:47], s31 offen offset:0 sc1
    buffer_load_dword v43, v5, s[44:47], s31 offen offset:640 sc1
    buffer_load_dword v44, v5, s[44:47], s31 offen offset:1280 sc1
    buffer_load_dword v45, v5, s[44:47], s31 offen offset:1920 sc1
    buffer_load_dword v46, v6, s[44:47], s31 offen offset:0 sc1
    buffer_load_dword v47, v6, s[44:47], s31 offen offset:640 sc1
    buffer_load_dword v48, v6, s[44:47], s31 offen offset:1280 sc1
    s_lshl_b32 s32, s28, 2
    s_add_u32 s32, s32, 131072
    v_lshl_add_u32 v23, v3, 5, s32
    s_lshl_b32 s32, s28, 11
    s_add_u32 s32, s32, 131072
    v_lshl_add_u32 v22, v0, 5, s32
    v_and_b32 v12, 7, v0
    v_cmp_ne_u32 s[34:35], 7, v12
    s_waitcnt vmcnt(8)
    s_cmp_eq_u32 s28, 0
    s_cbranch_scc0 L_nox2
    v_and_b32 v13, 31, v0
    v_lshlrev_b32 v13, 7, v13
    s_mov_b32 s33, 589824
    s_mov_b32 s59, 0
    s_branch L_poll_5_c
L_poll_5:
    buffer_load_dwordx2 v[18:19], v13, s[44:47], s33 offen sc1
L_poll_5_c:
    s_waitcnt vmcnt(0)
    v_bitop3_b32 v16, v19, v19, s98 bitop3:0x7e
    v_cmp_ne_u32 vcc, 0, v16
    s_nop 1
    s_cbranch_vccz L_poll_5_x
    s_add_u32 s59, s59, 1
    s_cmp_gt_u32 s59, 1048576
    s_cbranch_scc1 L_poll_5_x
    s_sleep 8
    s_branch L_poll_5
    .p2align 5
L_poll_5_x:
    v_cmp_ne_u32 vcc, s56, v18
    s_nop 1
    s_cmp_eq_u64 vcc, 0
    s_cselect_b32 s58, 1, 0
    v_mov_b32 v13, s58
    v_mov_b32 v14, 142336
    ds_write_b32 v14, v13
L_nox2:
    s_mov_b32 s59, 0
    s_branch L_poll_6_c
L_poll_6:
    buffer_load_dwordx4 v[52:55], v7, s[44:47], s31 offen offset:512 sc1
L_poll_6_c:
    s_waitcnt vmcnt(0)
    v_and_b32 v16, v53, v55
    v_or_b32 v17, v53, v55
    v_bitop3_b32 v16, v16, v17, s98 bitop3:0x7e
    v_cmp_ne_u32 vcc, 0, v16
    s_nop 1
    s_cbranch_vccz L_poll_6_x
    s_add_u32 s59, s59, 1
    s_cmp_gt_u32 s59, 1048576
    s_cbranch_scc1 L_poll_6_x
    s_sleep 8
    s_branch L_poll_6
    .p2align 5
L_poll_6_x:
    v_mov_b32 v40, v52
    v_mov_b32 v41, v54
    v_mov_b32 v16, v40
    s_nop 1
    v_max_f32_dpp v16, v16, v16 quad_perm:[1,0,3,2] row_mask:0xf bank_mask:0xf
    s_nop 1
    v_max_f32_dpp v16, v16, v16 quad_perm:[2,3,0,1] row_mask:0xf bank_mask:0xf
    s_nop 1
    v_max_f32_dpp v16, v16, v16 row_half_mirror row_mask:0xf bank_mask:0xf
    v_sub_f32 v16, v40, v16
    v_mul_f32 v16, 0x3fb8aa3b, v16
    v_exp_f32 v16, v16
    s_nop 0
    v_mul_f32 v17, v16, v41
    v_cndmask_b32 v17, 0, v17, s[34:35]
    s_nop 1
    v_add_f32_dpp v17, v17, v17 quad_perm:[1,0,3,2] row_mask:0xf bank_mask:0xf
    s_nop 1
    v_add_f32_dpp v17, v17, v17 quad_perm:[2,3,0,1] row_mask:0xf bank_mask:0xf
    s_nop 1
    v_add_f32_dpp v17, v17, v17 row_half_mirror row_mask:0xf bank_mask:0xf
    v_rcp_f32 v17, v17
    v_lshlrev_b32 v20, 16, v20
    v_mul_f32 v17, v16, v17
    s_mov_b32 s59, 0
    s_branch L_poll_8_c
L_poll_8:
    buffer_load_dword v42, v5, s[44:47], s31 offen offset:0 sc1
    buffer_load_dword v43, v5, s[44:47], s31 offen offset:640 sc1
    buffer_load_dword v44, v5, s[44:47], s31 offen offset:1280 sc1
    buffer_load_dword v45, v5, s[44:47], s31 offen offset:1920 sc1
    buffer_load_dword v46, v6, s[44:47], s31 offen offset:0 sc1
    buffer_load_dword v47, v6, s[44:47], s31 offen offset:640 sc1
    buffer_load_dword v48, v6, s[44:47], s31 offen offset:1280 sc1
L_poll_8_c:
    s_waitcnt vmcnt(0)
    v_xor_b32 v42, s99, v42
    v_xor_b32 v43, s99, v43
    v_xor_b32 v44, s99, v44
    v_xor_b32 v45, s99, v45
    v_xor_b32 v46, s99, v46
    v_xor_b32 v47, s99, v47
    v_xor_b32 v48, s99, v48
    v_or3_b32 v16, v42, v43, v44
    v_or3_b32 v16, v16, v45, v46
    v_or3_b32 v16, v16, v47, v48
    v_and_b32 v16, 0xff, v16
    v_cmp_ne_u32 vcc, 0, v16
    s_nop 1
    s_cbranch_vccz L_poll_8_x
    s_add_u32 s59, s59, 1
    s_cmp_gt_u32 s59, 1048576
    s_cbranch_scc1 L_poll_8_x
    s_sleep 1
    s_branch L_poll_8
    .p2align 5
L_poll_8_x:
    v_mul_f32_dpp v18, v17, v42 row_newbcast:0 row_mask:0xf bank_mask:0xf
    v_mul_f32_dpp v19, v17, v43 row_newbcast:1 row_mask:0xf bank_mask:0xf
    v_fmac_f32_dpp v18, v17, v44 row_newbcast:2 row_mask:0xf bank_mask:0xf
    v_fmac_f32_dpp v19, v17, v45 row_newbcast:3 row_mask:0xf bank_mask:0xf
    v_fmac_f32_dpp v18, v17, v46 row_newbcast:4 row_mask:0xf bank_mask:0xf
    v_fmac_f32_dpp v19, v17, v47 row_newbcast:5 row_mask:0xf bank_mask:0xf
    v_fmac_f32_dpp v18, v17, v48 row_newbcast:6 row_mask:0xf bank_mask:0xf
    s_waitcnt lgkmcnt(0)
    v_add_f32 v18, v18, v19
    s_nop 1
    v_mov_b32_dpp v19, v18 quad_perm:[1,1,3,3] row_mask:0xf bank_mask:0xf
    v_cvt_pk_bf16_f32 v19, v18, v19
    s_nop 1
    v_mov_b32_dpp v24, v19 row_newbcast:0 row_mask:0xf bank_mask:0xf
    v_mov_b32_dpp v25, v19 row_newbcast:2 row_mask:0xf bank_mask:0xf
    v_mov_b32_dpp v26, v19 row_newbcast:4 row_mask:0xf bank_mask:0xf
    v_mov_b32_dpp v27, v19 row_newbcast:6 row_mask:0xf bank_mask:0xf
    v_mov_b32_dpp v28, v19 row_newbcast:8 row_mask:0xf bank_mask:0xf
    v_mov_b32_dpp v29, v19 row_newbcast:10 row_mask:0xf bank_mask:0xf
    v_mov_b32_dpp v30, v19 row_newbcast:12 row_mask:0xf bank_mask:0xf
    v_mov_b32_dpp v31, v19 row_newbcast:14 row_mask:0xf bank_mask:0xf
    v_mfma_f32_16x16x32_bf16 v[32:35], v[24:27], v[64:67], 0
    ds_read_b64_tr_b16 v[176:177], v244 offset:0
    v_mfma_f32_16x16x32_bf16 v[36:39], v[24:27], v[68:71], 0
    ds_read_b64_tr_b16 v[178:179], v244 offset:512
    v_mfma_f32_16x16x32_bf16 v[40:43], v[24:27], v[72:75], 0
    ds_read_b64_tr_b16 v[180:181], v245 offset:0
    v_mfma_f32_16x16x32_bf16 v[44:47], v[24:27], v[76:79], 0
    ds_read_b64_tr_b16 v[182:183], v245 offset:512
    v_mfma_f32_16x16x32_bf16 v[48:51], v[24:27], v[80:83], 0
    ds_read_b64_tr_b16 v[184:185], v246 offset:0
    v_mfma_f32_16x16x32_bf16 v[52:55], v[24:27], v[84:87], 0
    ds_read_b64_tr_b16 v[186:187], v246 offset:512
    v_mfma_f32_16x16x32_bf16 v[56:59], v[24:27], v[88:91], 0
    ds_read_b64_tr_b16 v[188:189], v247 offset:0
    v_mfma_f32_16x16x32_bf16 v[60:63], v[24:27], v[92:95], 0
    ds_read_b64_tr_b16 v[190:191], v247 offset:512
    v_mfma_f32_16x16x32_bf16 v[32:35], v[28:31], v[96:99], v[32:35]
    ds_read_b64_tr_b16 v[192:193], v244 offset:3072
    v_mfma_f32_16x16x32_bf16 v[36:39], v[28:31], v[100:103], v[36:39]
    ds_read_b64_tr_b16 v[194:195], v244 offset:3584
    v_mfma_f32_16x16x32_bf16 v[40:43], v[28:31], v[104:107], v[40:43]
    ds_read_b64_tr_b16 v[196:197], v245 offset:3072
    v_mfma_f32_16x16x32_bf16 v[44:47], v[28:31], v[108:111], v[44:47]
    ds_read_b64_tr_b16 v[198:199], v245 offset:3584
    v_mfma_f32_16x16x32_bf16 v[48:51], v[28:31], v[112:115], v[48:51]
    ds_read_b64_tr_b16 v[200:201], v246 offset:3072
    v_mfma_f32_16x16x32_bf16 v[52:55], v[28:31], v[116:119], v[52:55]
    ds_read_b64_tr_b16 v[202:203], v246 offset:3584
    v_mfma_f32_16x16x32_bf16 v[56:59], v[28:31], v[120:123], v[56:59]
    ds_read_b64_tr_b16 v[204:205], v247 offset:3072
    v_mfma_f32_16x16x32_bf16 v[60:63], v[28:31], v[124:127], v[60:63]
    ds_read_b64_tr_b16 v[206:207], v247 offset:3584
    s_lshl_b32 s32, s29, 9
    s_add_u32 s32, s32, 425984
    s_lshl_b32 s31, s28, 8
    s_add_u32 s32, s32, s31
    v_lshl_add_u32 v5, v0, 2, s31
    v_add_u32 v6, 0x1000, v5
    v_mov_b32 v14, 142336
    v_lshlrev_b32 v12, 2, v0
    s_mov_b32 exec_lo, 0xffff
    s_mov_b32 exec_hi, 0
    ds_write2st64_b32 v23, v32, v36 offset0:0 offset1:2
    ds_write2st64_b32 v23, v40, v44 offset0:4 offset1:6
    ds_write2st64_b32 v23, v48, v52 offset0:8 offset1:10
    ds_write2st64_b32 v23, v56, v60 offset0:12 offset1:14
    s_mov_b64 exec, -1
    s_mov_b32 s33, 425984
    s_mov_b32 s31, 434176
    s_waitcnt lgkmcnt(0)
    s_barrier
    ds_read_b32 v15, v14
    s_cmp_ge_u32 s28, 2
    s_cbranch_scc1 L_b_skip
    ds_read_b128 v[40:43], v22
    ds_read_b128 v[44:47], v22 offset:16
    s_waitcnt lgkmcnt(0)
    v_readfirstlane_b32 s58, v15
    v_pk_add_f32 v[40:41], v[40:41], v[42:43]
    v_pk_add_f32 v[44:45], v[44:45], v[46:47]
    v_pk_add_f32 v[40:41], v[40:41], v[44:45]
    v_add_f32 v40, v40, v41
    v_and_or_b32 v40, v40, s100, v1
    s_cmp_eq_u32 s58, 0
    s_cbranch_scc1 L_st_9
    buffer_store_dword v40, v12, s[44:47], s32 offen
    s_branch L_st_9_x
L_st_9:
    buffer_store_dword v40, v12, s[44:47], s32 offen sc1
L_st_9_x:
L_b_skip:
    s_mov_b32 s41, 0xffff
    v_lshlrev_b32 v13, 5, v0
    v_add_u32 v13, 142464, v13
    ds_read_b128 v[208:211], v13
    ds_read_b128 v[212:215], v13 offset:16
    ds_read_b128 v[216:219], v13 offset:1536
    ds_read_b128 v[220:223], v13 offset:1552
    v_add_u32 v12, 135168, v5
    s_lshl_b32 s42, s29, 6
    s_add_u32 s42, s42, 135168
    v_lshl_add_u32 v7, v3, 2, s42
    v_and_b32 v13, 7, v0
    v_lshlrev_b32 v13, 3, v13
    v_add_u32 v13, 142400, v13
    s_lshl_b32 s42, s28, 3
    s_add_u32 s42, s42, 142400
    v_mov_b32 v14, s42
    s_waitcnt lgkmcnt(0)
    v_readfirstlane_b32 s58, v15
    v_pk_add_f32 v[208:209], v[208:209], v[210:211]
    v_pk_add_f32 v[212:213], v[212:213], v[214:215]
    v_pk_add_f32 v[208:209], v[208:209], v[212:213]
    v_add_f32 v208, v208, v209
    v_pk_add_f32 v[216:217], v[216:217], v[218:219]
    v_pk_add_f32 v[220:221], v[220:221], v[222:223]
    v_pk_add_f32 v[216:217], v[216:217], v[220:221]
    v_add_f32 v216, v216, v217
    buffer_load_dword v40, v5, s[44:47], s33 offen offset:0 sc1
    buffer_load_dword v41, v5, s[44:47], s33 offen offset:2048 sc1
    buffer_load_dword v42, v6, s[44:47], s33 offen offset:0 sc1
    buffer_load_dword v43, v6, s[44:47], s33 offen offset:2048 sc1
    buffer_load_dword v44, v5, s[44:47], s31 offen offset:0 sc1
    buffer_load_dword v45, v5, s[44:47], s31 offen offset:2048 sc1
    buffer_load_dword v46, v6, s[44:47], s31 offen offset:0 sc1
    buffer_load_dword v47, v6, s[44:47], s31 offen offset:2048 sc1
    s_mov_b32 s59, 0
    s_branch L_poll_10_c
L_poll_10:
    buffer_load_dword v40, v5, s[44:47], s33 offen offset:0 sc1
    buffer_load_dword v41, v5, s[44:47], s33 offen offset:2048 sc1
    buffer_load_dword v42, v6, s[44:47], s33 offen offset:0 sc1
    buffer_load_dword v43, v6, s[44:47], s33 offen offset:2048 sc1
    buffer_load_dword v44, v5, s[44:47], s31 offen offset:0 sc1
    buffer_load_dword v45, v5, s[44:47], s31 offen offset:2048 sc1
    buffer_load_dword v46, v6, s[44:47], s31 offen offset:0 sc1
    buffer_load_dword v47, v6, s[44:47], s31 offen offset:2048 sc1
L_poll_10_c:
    s_waitcnt vmcnt(0)
    v_xor_b32 v40, s99, v40
    v_xor_b32 v41, s99, v41
    v_xor_b32 v42, s99, v42
    v_xor_b32 v43, s99, v43
    v_xor_b32 v44, s99, v44
    v_xor_b32 v45, s99, v45
    v_xor_b32 v46, s99, v46
    v_xor_b32 v47, s99, v47
    v_or3_b32 v16, v40, v41, v42
    v_or3_b32 v16, v16, v43, v44
    v_or3_b32 v16, v16, v45, v46
    v_or_b32 v16, v16, v47
    v_and_b32 v16, 0xff, v16
    v_cmp_ne_u32 vcc, 0, v16
    s_nop 1
    s_cbranch_vccz L_poll_10_x
    s_add_u32 s59, s59, 1
    s_cmp_gt_u32 s59, 1048576
    s_cbranch_scc1 L_poll_10_x
    s_branch L_poll_10
    .p2align 5
L_poll_10_x:
    v_pk_add_f32 v[40:41], v[40:41], v[42:43]
    v_pk_add_f32 v[44:45], v[44:45], v[46:47]
    v_pk_add_f32 v[40:41], v[40:41], v[44:45]
    v_add_f32 v40, v40, v41
    v_add_f32 v40, v20, v40
    v_cvt_pk_bf16_f32 v40, v40, v40
    v_and_b32 v56, 0xffff0000, v40
    ds_write_b32 v12, v56
    v_mul_f32 v57, v56, v56
    v_mov_b32_dpp v19, v40 quad_perm:[1,1,3,3] row_mask:0xf bank_mask:0xf
    v_bfi_b32 v19, s41, v40, v19
    s_nop 1
    v_mov_b32_dpp v24, v19 row_newbcast:0 row_mask:0xf bank_mask:0xf
    v_mov_b32_dpp v25, v19 row_newbcast:2 row_mask:0xf bank_mask:0xf
    v_mov_b32_dpp v26, v19 row_newbcast:4 row_mask:0xf bank_mask:0xf
    v_mov_b32_dpp v27, v19 row_newbcast:6 row_mask:0xf bank_mask:0xf
    v_mov_b32_dpp v28, v19 row_newbcast:8 row_mask:0xf bank_mask:0xf
    v_mov_b32_dpp v29, v19 row_newbcast:10 row_mask:0xf bank_mask:0xf
    v_mov_b32_dpp v30, v19 row_newbcast:12 row_mask:0xf bank_mask:0xf
    v_mov_b32_dpp v31, v19 row_newbcast:14 row_mask:0xf bank_mask:0xf
    v_mfma_f32_16x16x32_bf16 v[32:35], v[24:27], v[128:131], 0
    v_add_f32_dpp v56, v56, v56 quad_perm:[1,0,3,2] row_mask:0xf bank_mask:0xf
    v_add_f32_dpp v57, v57, v57 quad_perm:[1,0,3,2] row_mask:0xf bank_mask:0xf
    v_mfma_f32_16x16x32_bf16 v[36:39], v[24:27], v[132:135], 0
    v_add_f32_dpp v56, v56, v56 quad_perm:[2,3,0,1] row_mask:0xf bank_mask:0xf
    v_add_f32_dpp v57, v57, v57 quad_perm:[2,3,0,1] row_mask:0xf bank_mask:0xf
    v_mfma_f32_16x16x32_bf16 v[40:43], v[24:27], v[136:139], 0
    v_add_f32_dpp v56, v56, v56 row_half_mirror row_mask:0xf bank_mask:0xf
    v_add_f32_dpp v57, v57, v57 row_half_mirror row_mask:0xf bank_mask:0xf
    v_mfma_f32_16x16x32_bf16 v[44:47], v[24:27], v[140:143], 0
    v_add_f32_dpp v56, v56, v56 row_mirror row_mask:0xf bank_mask:0xf
    v_add_f32_dpp v57, v57, v57 row_mirror row_mask:0xf bank_mask:0xf
    v_mfma_f32_16x16x32_bf16 v[48:51], v[24:27], v[144:147], 0
    v_add_f32_dpp v56, v56, v56 row_bcast:15 row_mask:0xa bank_mask:0xf
    v_add_f32_dpp v57, v57, v57 row_bcast:15 row_mask:0xa bank_mask:0xf
    v_mfma_f32_16x16x32_bf16 v[52:55], v[24:27], v[148:151], 0
    v_add_f32_dpp v56, v56, v56 row_bcast:31 row_mask:0xc bank_mask:0xf
    v_add_f32_dpp v57, v57, v57 row_bcast:31 row_mask:0xc bank_mask:0xf
    v_mfma_f32_16x16x32_bf16 v[32:35], v[28:31], v[152:155], v[32:35]
    v_mfma_f32_16x16x32_bf16 v[36:39], v[28:31], v[156:159], v[36:39]
    v_mfma_f32_16x16x32_bf16 v[40:43], v[28:31], v[160:163], v[40:43]
    v_mfma_f32_16x16x32_bf16 v[44:47], v[28:31], v[164:167], v[44:47]
    v_mfma_f32_16x16x32_bf16 v[48:51], v[28:31], v[168:171], v[48:51]
    v_mfma_f32_16x16x32_bf16 v[52:55], v[28:31], v[172:175], v[52:55]
    s_mov_b32 exec_lo, 0
    s_mov_b32 exec_hi, 0x80000000
    ds_write_b64 v14, v[56:57]
    s_mov_b64 exec, -1
    v_add_u32 v23, 6144, v23
    v_lshlrev_b32 v5, 5, v0
    v_add_u32 v5, 137216, v5
    s_lshl_b32 s32, s29, 11
    s_lshl_b32 s31, s28, 8
    s_add_u32 s32, s32, s31
    s_add_u32 s32, s32, 458752
    s_mov_b32 exec_lo, 0xffff
    s_mov_b32 exec_hi, 0
    ds_write2st64_b32 v23, v32, v36 offset0:0 offset1:2
    ds_write2st64_b32 v23, v40, v44 offset0:4 offset1:6
    ds_write2st64_b32 v23, v48, v52 offset0:8 offset1:10
    s_mov_b64 exec, -1
    s_waitcnt lgkmcnt(0)
    s_barrier
    ds_read_b64 v[56:57], v13
    ds_read_b128 v[40:43], v5
    ds_read_b128 v[44:47], v5 offset:16
    ds_read_b128 v[48:51], v5 offset:1536
    ds_read_b128 v[52:55], v5 offset:1552
    ds_read_b32 v20, v7
    v_mov_b32 v58, 0x3b000000
    s_waitcnt lgkmcnt(3)
    v_add_f32_dpp v56, v56, v56 quad_perm:[1,0,3,2] row_mask:0xf bank_mask:0xf
    v_add_f32_dpp v57, v57, v57 quad_perm:[1,0,3,2] row_mask:0xf bank_mask:0xf
    v_pk_add_f32 v[40:41], v[40:41], v[42:43]
    v_add_f32_dpp v56, v56, v56 quad_perm:[2,3,0,1] row_mask:0xf bank_mask:0xf
    v_add_f32_dpp v57, v57, v57 quad_perm:[2,3,0,1] row_mask:0xf bank_mask:0xf
    v_pk_add_f32 v[44:45], v[44:45], v[46:47]
    v_add_f32_dpp v56, v56, v56 row_half_mirror row_mask:0xf bank_mask:0xf
    v_add_f32_dpp v57, v57, v57 row_half_mirror row_mask:0xf bank_mask:0xf
    v_pk_add_f32 v[40:41], v[40:41], v[44:45]
    v_mul_f32 v56, v56, v58
    v_mul_f32 v57, v57, v58
    v_add_f32 v40, v40, v41
    v_fma_f32 v57, -v56, v56, v57
    v_fma_f32 v40, -v56, v208, v40
    v_max_f32 v57, 0, v57
    v_add_f32 v57, 0x3727c5ac, v57
    v_rsq_f32 v57, v57
    s_waitcnt lgkmcnt(0)
    v_pk_add_f32 v[48:49], v[48:49], v[50:51]
    v_mul_f32 v40, v40, v57
    v_mul_f32 v41, v40, v40
    v_pk_add_f32 v[52:53], v[52:53], v[54:55]
    v_mul_f32 v41, 0x3d372713, v41
    v_fma_f32 v41, v41, v40, v40
    v_pk_add_f32 v[48:49], v[48:49], v[52:53]
    v_mul_f32 v41, 0xc0135761, v41
    v_exp_f32 v41, v41
    v_add_f32 v48, v48, v49
    v_fma_f32 v48, -v56, v216, v48
    v_add_f32 v41, 1.0, v41
    v_rcp_f32 v41, v41
    v_mul_f32 v48, v48, v57
    v_mul_f32 v41, v41, v40
    v_mul_f32 v41, v41, v48
    v_cndmask_b32 v18, 0, v41, s[96:97]
    s_nop 1
    v_mov_b32_dpp v19, v18 quad_perm:[1,1,3,3] row_mask:0xf bank_mask:0xf
    v_cvt_pk_bf16_f32 v19, v18, v19
    s_nop 1
    v_mov_b32_dpp v24, v19 row_newbcast:0 row_mask:0xf bank_mask:0xf
    v_mov_b32_dpp v25, v19 row_newbcast:2 row_mask:0xf bank_mask:0xf
    v_mov_b32_dpp v26, v19 row_newbcast:4 row_mask:0xf bank_mask:0xf
    v_mov_b32_dpp v27, v19 row_newbcast:6 row_mask:0xf bank_mask:0xf
    v_mov_b32_dpp v28, v19 row_newbcast:8 row_mask:0xf bank_mask:0xf
    v_mov_b32_dpp v29, v19 row_newbcast:10 row_mask:0xf bank_mask:0xf
    v_mov_b32_dpp v30, v19 row_newbcast:12 row_mask:0xf bank_mask:0xf
    v_mov_b32_dpp v31, v19 row_newbcast:14 row_mask:0xf bank_mask:0xf
    v_mfma_f32_16x16x32_bf16 v[32:35], v[24:27], v[176:179], 0
    v_mfma_f32_16x16x32_bf16 v[36:39], v[24:27], v[180:183], 0
    v_mfma_f32_16x16x32_bf16 v[40:43], v[24:27], v[184:187], 0
    v_mfma_f32_16x16x32_bf16 v[44:47], v[24:27], v[188:191], 0
    v_mfma_f32_16x16x32_bf16 v[32:35], v[28:31], v[192:195], v[32:35]
    v_mfma_f32_16x16x32_bf16 v[36:39], v[28:31], v[196:199], v[36:39]
    v_mfma_f32_16x16x32_bf16 v[40:43], v[28:31], v[200:203], v[40:43]
    v_mfma_f32_16x16x32_bf16 v[44:47], v[28:31], v[204:207], v[44:47]
    s_mov_b32 s34, 0xffff0000
    s_mov_b32 s35, 0
    s_mov_b32 s42, 0
    s_mov_b32 s43, 0xffff0000
    s_lshl_b32 s31, s29, 6
    s_add_u32 s31, s31, 458752
    v_lshlrev_b32 v5, 11, v2
    v_lshl_add_u32 v5, v3, 2, v5
    v_lshlrev_b32 v6, 2, v0
    v_cndmask_b32 v32, v32, v36, s[34:35]
    v_cndmask_b32 v40, v40, v44, s[42:43]
    v_cmp_lt_u32 vcc, 31, v0
    s_nop 1
    v_cndmask_b32 v32, v32, v40, vcc
    v_and_or_b32 v32, v32, s100, v1
    s_cmp_eq_u32 s58, 0
    s_cbranch_scc1 L_st_11
    buffer_store_dword v32, v6, s[44:47], s32 offen
    s_branch L_st_11_x
L_st_11:
    buffer_store_dword v32, v6, s[44:47], s32 offen sc1
L_st_11_x:
    s_cmp_eq_u32 s28, 0
    s_cbranch_scc1 L_final
    s_cmp_eq_u32 s28, 1
    s_cbranch_scc0 L_fin
    s_cmp_eq_u32 s29, 0
    s_cbranch_scc0 L_fin
    v_mov_b32 v40, s101
    v_lshlrev_b32 v5, 2, v0
    s_mov_b32 s31, 598016
    s_mov_b32 exec_lo, 0xffffffff
    s_mov_b32 exec_hi, 0
    buffer_store_dword v40, v5, s[44:47], s31 offen sc1
    s_branch L_fin
L_final:
    s_add_u32 s33, s31, 8192
    s_add_u32 s34, s31, 16384
    s_add_u32 s35, s31, 24576
    s_add_u32 s52, s31, 32768
    s_add_u32 s53, s31, 40960
    s_add_u32 s54, s31, 49152
    s_add_u32 s55, s31, 57344
    buffer_load_dword v40, v5, s[44:47], s31 offen sc1
    buffer_load_dword v41, v5, s[44:47], s33 offen sc1
    buffer_load_dword v42, v5, s[44:47], s34 offen sc1
    buffer_load_dword v43, v5, s[44:47], s35 offen sc1
    buffer_load_dword v44, v5, s[44:47], s52 offen sc1
    buffer_load_dword v45, v5, s[44:47], s53 offen sc1
    buffer_load_dword v46, v5, s[44:47], s54 offen sc1
    buffer_load_dword v47, v5, s[44:47], s55 offen sc1
    s_mov_b32 s60, s22
    s_mov_b32 s61, s23
    s_mov_b32 s62, 1024
    s_mov_b32 s63, 0x20000
    s_lshl_b32 s42, s29, 5
    v_lshlrev_b32 v6, 1, v3
    s_mov_b32 s59, 0
    s_branch L_poll_12_c
L_poll_12:
    buffer_load_dword v40, v5, s[44:47], s31 offen sc1
    buffer_load_dword v41, v5, s[44:47], s33 offen sc1
    buffer_load_dword v42, v5, s[44:47], s34 offen sc1
    buffer_load_dword v43, v5, s[44:47], s35 offen sc1
    buffer_load_dword v44, v5, s[44:47], s52 offen sc1
    buffer_load_dword v45, v5, s[44:47], s53 offen sc1
    buffer_load_dword v46, v5, s[44:47], s54 offen sc1
    buffer_load_dword v47, v5, s[44:47], s55 offen sc1
L_poll_12_c:
    s_waitcnt vmcnt(0)
    v_xor_b32 v40, s99, v40
    v_xor_b32 v41, s99, v41
    v_xor_b32 v42, s99, v42
    v_xor_b32 v43, s99, v43
    v_xor_b32 v44, s99, v44
    v_xor_b32 v45, s99, v45
    v_xor_b32 v46, s99, v46
    v_xor_b32 v47, s99, v47
    v_or3_b32 v16, v40, v41, v42
    v_or3_b32 v16, v16, v43, v44
    v_or3_b32 v16, v16, v45, v46
    v_or_b32 v16, v16, v47
    v_and_b32 v16, 0xff, v16
    v_cmp_ne_u32 vcc, 0, v16
    s_nop 1
    s_cbranch_vccz L_poll_12_x
    s_add_u32 s59, s59, 1
    s_cmp_gt_u32 s59, 1048576
    s_cbranch_scc1 L_poll_12_x
    s_branch L_poll_12
    .p2align 5
L_poll_12_x:
    v_pk_add_f32 v[40:41], v[40:41], v[42:43]
    v_pk_add_f32 v[44:45], v[44:45], v[46:47]
    v_pk_add_f32 v[40:41], v[40:41], v[44:45]
    v_add_f32 v40, v40, v41
    v_mov_b32 v41, v40
    s_nop 1
    v_permlane16_swap_b32 v40, v41
    s_nop 1
    v_add_f32 v40, v40, v41
    v_mov_b32 v41, v40
    s_nop 1
    v_permlane32_swap_b32 v40, v41
    s_nop 1
    v_add_f32 v40, v40, v41
    v_cvt_pk_bf16_f32 v40, v40, v40
    v_and_b32 v40, 0xffff0000, v40
    v_add_f32 v40, v20, v40
    v_cvt_pk_bf16_f32 v40, v40, v40
    s_mov_b32 exec_lo, 0xffff
    s_mov_b32 exec_hi, 0
    buffer_store_short v40, v6, s[60:63], s42 offen
L_fin:
L_end:
    s_endpgm

.section .rodata,"a"
.p2align 6
.amdhsa_kernel sequential_preLN__mha_block_cached__geglu_ffn__decode_kernel
  .amdhsa_next_free_vgpr 256
  .amdhsa_next_free_sgpr 102
  .amdhsa_accum_offset 256
  .amdhsa_group_segment_fixed_size 0
  .amdhsa_kernarg_size 96
  .amdhsa_user_sgpr_count 2
  .amdhsa_user_sgpr_kernarg_segment_ptr 1
  .amdhsa_system_sgpr_workgroup_id_x 1
  .amdhsa_float_denorm_mode_32 3
  .amdhsa_float_denorm_mode_16_64 3
.end_amdhsa_kernel
.text
```
